```python
import torch

def _softmax(x, axis=-1):
    return torch.softmax(x, dim=axis)
def _gelu(x):
    return torch.nn.functional.gelu(x, approximate="tanh")
def _silu(x):
    return torch.nn.functional.silu(x)
def _sigmoid(x):
    return torch.sigmoid(x)
def _layernorm(x, axis=-1, eps=1e-5):
    m = x.mean(dim=axis, keepdim=True)
    v = x.var(dim=axis, keepdim=True, unbiased=False)
    return (x - m) / torch.sqrt(v + eps)
def _scatter_add(tgt, idx, src, axis=0):
    return tgt.clone().index_add_(axis, idx, src)
def _segment_sum(src, seg, n):
    out = torch.zeros((n,) + src.shape[1:], dtype=src.dtype)
    return out.index_add_(0, seg, src)
def _pad(x, pw):
    flat = tuple(v for pair in reversed(pw) for v in pair)
    return torch.nn.functional.pad(x, flat)

kernel_name = 'interleave_layers__gqa_block_cached__gqa_block_cached__decode'

def setup_inputs():

    _w = (lambda a: (lambda t: t.to(torch.bfloat16) if t.is_floating_point() else t)(torch.as_tensor(a)))
    def _A_setup():
        B, Sq, D = 8, 1, 512
        Hq, Hkv, Sk, Dh = 32, 8, 4096, 128
        assert Hq % Hkv == 0, (Hq, Hkv)
        return {
            "x": _w((lambda *s: torch.randn(*s, dtype=torch.bfloat16) * 0.1)(B, Sq, D)),
            "k_cache": _w((lambda *s: torch.randn(*s, dtype=torch.bfloat16) * 0.8)(B, Hkv, Sk, Dh)),
            "v_cache": _w((lambda *s: torch.randn(*s, dtype=torch.bfloat16) * 3.2)(B, Hkv, Sk, Dh)),
            "wq": _w((lambda *s: torch.randn(*s, dtype=torch.bfloat16) * 0.8)(D, Hq * Dh) * (D ** -0.5)),
            "wo": _w((lambda *s: torch.randn(*s, dtype=torch.bfloat16) * 3.2)(Hq * Dh, D) * ((Hq * Dh) ** -0.5)),
        }
    _A_in = _A_setup()

    def _B_setup():
        B, Sq, D = 8, 1, 512
        Hq, Hkv, Sk, Dh = 32, 8, 4096, 128
        assert Hq % Hkv == 0, (Hq, Hkv)
        return {
            "x": _w((lambda *s: torch.randn(*s, dtype=torch.bfloat16) * 0.1)(B, Sq, D)),
            "k_cache": _w((lambda *s: torch.randn(*s, dtype=torch.bfloat16) * 1.6)(B, Hkv, Sk, Dh)),
            "v_cache": _w((lambda *s: torch.randn(*s, dtype=torch.bfloat16) * 1.6)(B, Hkv, Sk, Dh)),
            "wq": _w((lambda *s: torch.randn(*s, dtype=torch.bfloat16) * 1.6)(D, Hq * Dh) * (D ** -0.5)),
            "wo": _w((lambda *s: torch.randn(*s, dtype=torch.bfloat16) * 1.6)(Hq * Dh, D) * ((Hq * Dh) ** -0.5)),
        }
    _B_in = _B_setup()

    return {
        "A_x": _A_in["x"],
        "A_k_cache": _A_in["k_cache"],
        "A_v_cache": _A_in["v_cache"],
        "A_wq": _A_in["wq"],
        "A_wo": _A_in["wo"],
        "B_x": _B_in["x"],
        "B_k_cache": _B_in["k_cache"],
        "B_v_cache": _B_in["v_cache"],
        "B_wq": _B_in["wq"],
        "B_wo": _B_in["wo"],
    }

def reference(A_x, A_k_cache, A_v_cache, A_wq, A_wo, B_x, B_k_cache, B_v_cache, B_wq, B_wo):
    def _A_ref(x, k_cache, v_cache, wq, wo):
        B, Sq, D = x.shape
        Hq, Dh = 32, 128
        Hkv = k_cache.shape[1]
        rep = Hq // Hkv
        q = (lambda x, *d: x.permute(*d))((x @ wq).reshape(B, Sq, Hq, Dh), 0, 2, 1, 3)
        k = (lambda x, n, axis: torch.repeat_interleave(x, n, dim=axis))(k_cache, rep, axis=1)
        v = (lambda x, n, axis: torch.repeat_interleave(x, n, dim=axis))(v_cache, rep, axis=1)
        scores = torch.einsum("bhqd,bhkd->bhqk", q, k) * (Dh ** -0.5)
        p = _softmax(scores, axis=-1)
        o = torch.einsum("bhqk,bhkd->bhqd", p, v)
        return (lambda x, *d: x.permute(*d))(o, 0, 2, 1, 3).reshape(B, Sq, Hq * Dh) @ wo

    def _B_ref(x, k_cache, v_cache, wq, wo):
        B, Sq, D = x.shape
        Hq, Dh = 32, 128
        Hkv = k_cache.shape[1]
        rep = Hq // Hkv
        q = (lambda x, *d: x.permute(*d))((x @ wq).reshape(B, Sq, Hq, Dh), 0, 2, 1, 3)
        k = (lambda x, n, axis: torch.repeat_interleave(x, n, dim=axis))(k_cache, rep, axis=1)
        v = (lambda x, n, axis: torch.repeat_interleave(x, n, dim=axis))(v_cache, rep, axis=1)
        scores = torch.einsum("bhqd,bhkd->bhqk", q, k) * (Dh ** -0.5)
        p = _softmax(scores, axis=-1)
        o = torch.einsum("bhqk,bhkd->bhqd", p, v)
        return (lambda x, *d: x.permute(*d))(o, 0, 2, 1, 3).reshape(B, Sq, Hq * Dh) @ wo

    x = A_x
    x = x + _A_ref(_layernorm(x, axis=-1), A_k_cache, A_v_cache, A_wq, A_wo)
    x = x + _B_ref(_layernorm(x, axis=-1), B_k_cache, B_v_cache, B_wq, B_wo)
    x = x + _A_ref(_layernorm(x, axis=-1), A_k_cache, A_v_cache, A_wq, A_wo)
    x = x + _B_ref(_layernorm(x, axis=-1), B_k_cache, B_v_cache, B_wq, B_wo)
    return x
```

```asm
; @launch grid=(256,1,1) block=(256,1,1) lds=163840
.amdgcn_target "amdgcn-amd-amdhsa--gfx950"
.text
.globl interleave_layers__gqa_block_cached__gqa_block_cached__decode_kernel
.p2align 8
.type interleave_layers__gqa_block_cached__gqa_block_cached__decode_kernel,@function
interleave_layers__gqa_block_cached__gqa_block_cached__decode_kernel:

    s_cmp_ge_u32 s2, 256
    s_cbranch_scc1 L_end
    s_load_dwordx2 s[12:13], s[0:1], 0
    s_load_dwordx4 s[16:19], s[0:1], 8
    s_load_dwordx4 s[20:23], s[0:1], 48
    s_load_dwordx4 s[64:67], s[0:1], 24
    s_load_dwordx4 s[68:71], s[0:1], 64
    s_load_dwordx4 s[8:11], s[0:1], 80
    s_load_dwordx2 s[6:7], s[0:1], 96
    v_lshrrev_b32 v22, 6, v0
    v_and_b32 v1, 63, v0
    v_readfirstlane_b32 s3, v22
    s_getpc_b64 s[44:45]
    v_lshlrev_b32 v23, 4, v0
    s_and_b32 s44, s44, 0xffffff00
    global_load_dwordx4 v[124:127], v23, s[44:45]
    s_add_u32 s44, s44, 4096
    s_addc_u32 s45, s45, 0
    global_load_dwordx4 v[124:127], v23, s[44:45]
    s_add_u32 s44, s44, 4096
    s_addc_u32 s45, s45, 0
    global_load_dwordx4 v[124:127], v23, s[44:45]
    s_add_u32 s44, s44, 4096
    s_addc_u32 s45, s45, 0
    global_load_dwordx4 v[124:127], v23, s[44:45]
    s_add_u32 s44, s44, 4096
    s_addc_u32 s45, s45, 0
    global_load_dwordx4 v[124:127], v23, s[44:45]
    s_add_u32 s44, s44, 4096
    s_addc_u32 s45, s45, 0
    global_load_dwordx4 v[124:127], v23, s[44:45]
    s_add_u32 s44, s44, 4096
    s_addc_u32 s45, s45, 0
    s_and_b32 s4, s2, 7
    s_lshr_b32 s5, s2, 3
    s_lshr_b32 s52, s5, 3
    s_and_b32 s53, s5, 7
    v_lshrrev_b32 v22, 4, v1
    v_and_b32 v23, 15, v1
    v_lshlrev_b32 v24, 1, v22
    v_xor_b32 v24, v24, v23
    v_lshlrev_b32 v24, 4, v24
    v_lshl_add_u32 v8, v22, 8, v24
    v_xor_b32 v9, 128, v8
    v_add_u32 v9, 31744, v9
    s_lshl_b32 s48, s52, 23
    s_lshl_b32 s49, s4, 20
    s_add_u32 s48, s48, s49
    s_lshl_b32 s49, s53, 12
    s_add_u32 s48, s48, s49
    s_lshl_b32 s49, s3, 10
    s_add_u32 s48, s48, s49
    s_lshl_b32 s49, s3, 14
    s_mov_b32 s101, 129024
    s_lshl_b32 s101, s52, 1
    s_add_u32 s101, s101, s4
    s_and_b32 s101, s101, 7
    s_lshl_b32 s101, s101, 16
    s_mov_b32 s24, 0
    s_mov_b32 s25, 32
    s_add_u32 s26, s49, 0
    s_mov_b32 s90, 64
    s_mov_b32 s54, 8
    s_mov_b32 s55, 8
    s_mov_b32 s56, 5
    s_waitcnt lgkmcnt(0)
    s_add_u32 s16, s16, s48
    s_addc_u32 s17, s17, 0
    s_cmp_ge_u32 s24, s25
    s_cbranch_scc1 Lpk_1
    s_mov_b32 m0, s26
    s_add_u32 s0, s16, s101
    s_addc_u32 s1, s17, 0
    s_add_u32 s24, s24, 2
    global_load_lds_dwordx4 v8, s[0:1] nt
    global_load_lds_dwordx4 v9, s[0:1] offset:1024 nt
    s_add_u32 s101, s101, 65536
    s_and_b32 s101, s101, 0x7ffff
    s_add_u32 s26, s26, 2048
    s_and_b32 s0, s24, 15
    s_cbranch_scc0 Lps_2
Lpk_1:
    s_cmp_ge_u32 s24, s25
    s_cbranch_scc1 Lpk_3
    s_mov_b32 m0, s26
    s_add_u32 s0, s16, s101
    s_addc_u32 s1, s17, 0
    s_add_u32 s24, s24, 2
    global_load_lds_dwordx4 v8, s[0:1] nt
    global_load_lds_dwordx4 v9, s[0:1] offset:1024 nt
    s_add_u32 s101, s101, 65536
    s_and_b32 s101, s101, 0x7ffff
    s_add_u32 s26, s26, 2048
    s_and_b32 s0, s24, 15
    s_cbranch_scc0 Lps_4
Lpk_3:
    s_add_u32 s18, s18, s48
    s_addc_u32 s19, s19, 0
    s_add_u32 s20, s20, s48
    s_addc_u32 s21, s21, 0
    s_add_u32 s22, s22, s48
    s_addc_u32 s23, s23, 0
    s_lshl_b32 s48, s53, 19
    s_lshl_b32 s49, s3, 17
    s_add_u32 s48, s48, s49
    s_lshl_b32 s49, s4, 10
    s_add_u32 s48, s48, s49
    s_lshl_b32 s49, s52, 8
    s_add_u32 s50, s48, s49
    v_lshrrev_b32 v22, 4, v1
    v_lshlrev_b32 v22, 13, v22
    v_and_b32 v23, 15, v1
    v_lshl_add_u32 v22, v23, 4, v22
    s_add_u32 s44, s64, s50
    s_addc_u32 s45, s65, 0
    global_load_dwordx4 v[240:243], v22, s[44:45] nt
    s_add_u32 s44, s44, 32768
    s_addc_u32 s45, s45, 0
    global_load_dwordx4 v[244:247], v22, s[44:45] nt
    s_add_u32 s44, s44, 32768
    s_addc_u32 s45, s45, 0
    global_load_dwordx4 v[248:251], v22, s[44:45] nt
    s_add_u32 s44, s44, 32768
    s_addc_u32 s45, s45, 0
    global_load_dwordx4 v[252:255], v22, s[44:45] nt
    v_lshrrev_b32 v24, 4, v1
    v_and_b32 v24, 1, v24
    v_lshlrev_b32 v24, 12, v24
    v_and_b32 v25, 15, v1
    v_lshl_add_u32 v24, v25, 3, v24
    s_lshl_b32 s48, s3, 10
    s_lshl_b32 s49, s53, 7
    s_add_u32 s48, s48, s49
    v_add_u32 v24, s48, v24
    global_load_dwordx2 v[26:27], v24, s[12:13]
    s_cmp_ge_u32 s24, s25
    s_cbranch_scc1 Lpk_5
    s_mov_b32 m0, s26
    s_add_u32 s0, s16, s101
    s_addc_u32 s1, s17, 0
    s_add_u32 s24, s24, 2
    global_load_lds_dwordx4 v8, s[0:1] nt
    global_load_lds_dwordx4 v9, s[0:1] offset:1024 nt
    s_add_u32 s101, s101, 65536
    s_and_b32 s101, s101, 0x7ffff
    s_add_u32 s26, s26, 2048
    s_and_b32 s0, s24, 15
    s_cbranch_scc0 Lps_6
Lpk_5:
    s_mov_b32 s12, s14
    s_mov_b32 s13, 128
    v_lshlrev_b32 v35, 4, v1
    s_lshl_b32 s40, s2, 7
    s_add_u32 s40, s40, 12582912
    v_mov_b32 v58, -1
    v_mov_b32 v59, -1
    v_mov_b32 v60, -1
    v_mov_b32 v61, -1
    v_mov_b32 v50, 0
    v_mov_b32 v51, 0
    v_mov_b32 v52, 0
    v_mov_b32 v53, 0
    s_lshl_b32 s48, s4, 16
    s_lshl_b32 s49, s5, 11
    s_add_u32 s51, s48, s49
    s_and_b32 s49, s3, 1
    s_lshl_b32 s49, s49, 10
    s_add_u32 s48, s51, s49
    s_cmp_ge_u32 s3, 2
    s_cselect_b32 s49, 1310720, 0
    s_add_u32 s48, s48, s49
    s_add_u32 s48, s48, 1048576
    v_add_u32 v56, s48, v35
    global_store_dwordx4 v56, v[58:61], s[6:7] sc1
    v_add_u32 v56, 2097152, v56
    global_store_dwordx4 v56, v[58:61], s[6:7] sc1
    s_and_b32 s49, s3, 1
    s_mul_i32 s49, s49, 2097152
    s_add_u32 s49, s49, 1048576
    s_lshl_b32 s48, s2, 10
    s_add_u32 s48, s48, s49
    s_add_u32 s48, s48, 1048576
    v_add_u32 v56, s48, v35
    s_lshl_b32 s48, s4, 10
    s_lshl_b32 s50, s5, 5
    s_add_u32 s48, s48, s50
    s_cmp_lt_u32 s3, 2
    s_cbranch_scc1 L_inv2
    v_mov_b32 v56, s40
    s_add_u32 s49, s48, s49
    s_add_u32 s50, s49, 1843168
    s_mov_b64 exec, 15
    v_add_u32 v56, s50, v35
    s_add_u32 s50, s49, 1835008
    s_mov_b64 exec, 3
    v_add_u32 v56, s50, v35
    s_mov_b64 exec, 31
L_inv2:
    global_store_dwordx4 v56, v[58:61], s[6:7] sc1
    s_mov_b64 exec, -1
    s_add_u32 s48, s48, 7077120
    v_add_u32 v55, s48, v35
    s_lshl_b32 s48, s2, 10
    s_lshl_b32 s49, s3, 8
    s_add_u32 s48, s48, s49
    s_add_u32 s48, s48, 6290944
    s_mov_b32 exec_hi, 0xffff
    v_add_u32 v55, s48, v35
    s_lshl_b32 s49, s3, 9
    s_add_u32 s48, s51, s49
    s_add_u32 s48, s48, 5242880
    s_mov_b32 exec_hi, 0
    v_add_u32 v55, s48, v35
    s_mov_b32 exec_hi, 0x3ffff
    global_store_dwordx4 v55, v[50:53], s[6:7] sc1
    s_mov_b64 exec, -1
    s_cmp_ge_u32 s24, s25
    s_cbranch_scc1 Lpk_7
    s_mov_b32 m0, s26
    s_add_u32 s0, s16, s101
    s_addc_u32 s1, s17, 0
    s_add_u32 s24, s24, 2
    global_load_lds_dwordx4 v8, s[0:1] nt
    global_load_lds_dwordx4 v9, s[0:1] offset:1024 nt
    s_add_u32 s101, s101, 65536
    s_and_b32 s101, s101, 0x7ffff
    s_add_u32 s26, s26, 2048
    s_and_b32 s0, s24, 15
    s_cbranch_scc0 Lps_8
Lpk_7:
    s_lshl_b32 s48, s53, 19
    s_lshl_b32 s49, s3, 17
    s_add_u32 s48, s48, s49
    s_lshl_b32 s49, s4, 10
    s_add_u32 s48, s48, s49
    s_lshl_b32 s49, s52, 8
    s_add_u32 s50, s48, s49
    v_lshrrev_b32 v22, 4, v1
    v_lshlrev_b32 v22, 13, v22
    v_and_b32 v23, 15, v1
    v_lshl_add_u32 v22, v23, 4, v22
    s_add_u32 s44, s68, s50
    s_addc_u32 s45, s69, 0
    global_load_dwordx4 v[192:195], v22, s[44:45] nt
    s_add_u32 s44, s44, 32768
    s_addc_u32 s45, s45, 0
    global_load_dwordx4 v[196:199], v22, s[44:45] nt
    s_add_u32 s44, s44, 32768
    s_addc_u32 s45, s45, 0
    global_load_dwordx4 v[200:203], v22, s[44:45] nt
    s_add_u32 s44, s44, 32768
    s_addc_u32 s45, s45, 0
    global_load_dwordx4 v[204:207], v22, s[44:45] nt
    s_cmp_ge_u32 s24, s25
    s_cbranch_scc1 Lpk_9
    s_mov_b32 m0, s26
    s_add_u32 s0, s16, s101
    s_addc_u32 s1, s17, 0
    s_add_u32 s24, s24, 2
    global_load_lds_dwordx4 v8, s[0:1] nt
    global_load_lds_dwordx4 v9, s[0:1] offset:1024 nt
    s_add_u32 s101, s101, 65536
    s_and_b32 s101, s101, 0x7ffff
    s_add_u32 s26, s26, 2048
    s_and_b32 s0, s24, 15
    s_cbranch_scc0 Lps_10
Lpk_9:
    s_lshl_b32 s48, s4, 19
    s_lshl_b32 s49, s52, 17
    s_add_u32 s48, s48, s49
    s_lshl_b32 s49, s3, 15
    s_add_u32 s48, s48, s49
    s_lshl_b32 s49, s53, 7
    s_add_u32 s50, s48, s49
    v_lshrrev_b32 v22, 3, v1
    v_lshlrev_b32 v22, 10, v22
    v_and_b32 v23, 7, v1
    v_lshl_add_u32 v22, v23, 4, v22
    s_add_u32 s44, s66, s50
    s_addc_u32 s45, s67, 0
    global_load_dwordx4 v[208:211], v22, s[44:45] nt
    s_add_u32 s44, s44, 8192
    s_addc_u32 s45, s45, 0
    global_load_dwordx4 v[212:215], v22, s[44:45] nt
    s_add_u32 s44, s44, 8192
    s_addc_u32 s45, s45, 0
    global_load_dwordx4 v[216:219], v22, s[44:45] nt
    s_add_u32 s44, s44, 8192
    s_addc_u32 s45, s45, 0
    global_load_dwordx4 v[220:223], v22, s[44:45] nt
    s_cmp_ge_u32 s24, s25
    s_cbranch_scc1 Lpk_11
    s_mov_b32 m0, s26
    s_add_u32 s0, s16, s101
    s_addc_u32 s1, s17, 0
    s_add_u32 s24, s24, 2
    global_load_lds_dwordx4 v8, s[0:1] nt
    global_load_lds_dwordx4 v9, s[0:1] offset:1024 nt
    s_add_u32 s101, s101, 65536
    s_and_b32 s101, s101, 0x7ffff
    s_add_u32 s26, s26, 2048
    s_and_b32 s0, s24, 15
    s_cbranch_scc0 Lps_12
Lpk_11:
    s_add_u32 s44, s70, s50
    s_addc_u32 s45, s71, 0
    global_load_dwordx4 v[224:227], v22, s[44:45] nt
    s_add_u32 s44, s44, 8192
    s_addc_u32 s45, s45, 0
    global_load_dwordx4 v[228:231], v22, s[44:45] nt
    s_add_u32 s44, s44, 8192
    s_addc_u32 s45, s45, 0
    global_load_dwordx4 v[232:235], v22, s[44:45] nt
    s_add_u32 s44, s44, 8192
    s_addc_u32 s45, s45, 0
    global_load_dwordx4 v[236:239], v22, s[44:45] nt
    s_cmp_ge_u32 s24, s25
    s_cbranch_scc1 Lpk_13
    s_mov_b32 m0, s26
    s_add_u32 s0, s16, s101
    s_addc_u32 s1, s17, 0
    s_add_u32 s24, s24, 2
    global_load_lds_dwordx4 v8, s[0:1] nt
    global_load_lds_dwordx4 v9, s[0:1] offset:1024 nt
    s_add_u32 s101, s101, 65536
    s_and_b32 s101, s101, 0x7ffff
    s_add_u32 s26, s26, 2048
    s_and_b32 s0, s24, 15
    s_cbranch_scc0 Lps_14
Lpk_13:
    s_mov_b32 s34, 0
    s_mov_b64 s[84:85], s[66:67]
    s_mov_b64 s[86:87], s[70:71]
    s_mov_b32 s35, 0
    s_mov_b32 s91, 0
    s_mov_b32 s100, 0
    s_mov_b32 s36, 2
    s_mov_b32 s95, 2
    s_mov_b32 s31, 0
    s_mov_b32 s28, 0
    s_mov_b32 s30, 0
    s_mov_b32 s88, 0
    s_mov_b32 s57, 0x3e0293ee
    s_mov_b32 s98, 0x000f000f
    s_mov_b32 s99, 0x000f000f
    v_and_b32 v37, 31, v1
    v_lshrrev_b32 v28, 5, v1
    v_lshrrev_b32 v29, 4, v1
    v_and_b32 v30, 3, v1
    v_and_b32 v31, 7, v1
    v_lshlrev_b32 v4, 3, v37
    v_lshl_add_u32 v4, v28, 2, v4
    v_lshlrev_b32 v37, 4, v37
    s_lshl_b32 s48, s4, 16
    s_lshl_b32 s49, s52, 14
    s_add_u32 s49, s48, s49
    s_lshl_b32 s50, s3, 12
    s_add_u32 s49, s49, s50
    v_add_u32 v2, s49, v35
    s_lshl_b32 s49, s3, 14
    s_add_u32 s49, s48, s49
    s_lshl_b32 s50, s52, 12
    s_add_u32 s49, s49, s50
    s_lshl_b32 s50, s53, 9
    s_add_u32 s49, s49, s50
    v_lshl_add_u32 v3, v4, 1, s49
    s_lshl_b32 s49, s52, 12
    s_add_u32 s49, s48, s49
    s_add_u32 s49, s49, s50
    s_lshl_b32 s50, s3, 7
    s_add_u32 s49, s49, s50
    s_add_u32 s49, s49, 1310720
    v_lshlrev_b32 v7, 14, v30
    v_lshl_add_u32 v7, v29, 4, v7
    v_add_u32 v7, s49, v7
    s_lshl_b32 s48, s4, 10
    s_lshl_b32 s49, s3, 8
    s_add_u32 s49, s48, s49
    s_lshl_b32 s50, s52, 6
    s_add_u32 s49, s49, s50
    s_lshl_b32 s50, s53, 3
    s_add_u32 s38, s49, s50
    s_add_u32 s89, s38, 1835008
    s_add_u32 s38, s38, 1843200
    s_lshl_b32 s49, s52, 8
    s_add_u32 s49, s48, s49
    s_lshl_b32 s50, s3, 6
    s_add_u32 s49, s49, s50
    s_add_u32 s49, s49, 1835008
    v_xor_b32 v5, v31, v28
    v_lshl_add_u32 v5, v5, 3, s49
    s_lshl_b32 s48, s53, 15
    s_lshl_b32 s49, s4, 10
    s_add_u32 s48, s48, s49
    s_lshl_b32 s49, s52, 8
    s_add_u32 s48, s48, s49
    s_lshl_b32 s49, s3, 6
    s_add_u32 s48, s48, s49
    s_add_u32 s48, s48, 1048576
    v_lshlrev_b32 v6, 13, v30
    v_lshl_add_u32 v6, v29, 4, v6
    v_add_u32 v6, s48, v6
    v_bfe_u32 v32, v1, 2, 2
    v_and_b32 v33, 1, v32
    v_lshlrev_b32 v33, 3, v33
    v_lshl_add_u32 v33, v30, 1, v33
    v_xor_b32 v33, v33, v29
    v_lshlrev_b32 v33, 4, v33
    v_lshl_add_u32 v33, v30, 8, v33
    v_lshl_add_u32 v10, v32, 10, v33
    s_lshl_b32 s48, s3, 14
    s_add_u32 s49, s48, 0
    v_add_u32 v10, s49, v10
    v_and_b32 v33, 1, v29
    v_lshlrev_b32 v33, 3, v33
    v_lshl_add_u32 v33, v32, 1, v33
    v_bfe_u32 v34, v1, 1, 1
    v_xor_b32 v33, v33, v34
    v_lshlrev_b32 v33, 4, v33
    v_and_b32 v34, 1, v1
    v_lshl_add_u32 v33, v34, 3, v33
    v_lshl_add_u32 v33, v32, 8, v33
    v_lshl_add_u32 v11, v29, 10, v33
    s_add_u32 s49, s48, 65536
    v_add_u32 v11, s49, v11
    v_mul_u32_u24 v12, 272, v30
    v_lshl_add_u32 v12, v29, 4, v12
    v_add_u32 v12, 148224, v12
    v_lshlrev_b32 v0, 4, v29
    v_add_u32 v0, 149312, v0
    v_cndmask_b32 v0, v0, v12, s[98:99]
    v_mul_u32_u24 v13, 528, v30
    v_lshl_add_u32 v13, v29, 4, v13
    s_mul_i32 s48, s3, 2112
    s_add_u32 s48, s48, 131072
    v_add_u32 v13, s48, v13
    v_mul_u32_u24 v14, 4224, v28
    v_add_u32 v14, v14, v37
    s_mul_i32 s48, s3, 528
    s_add_u32 s48, s48, 131072
    v_add_u32 v14, s48, v14
    v_and_b32 v31, 15, v1
    v_lshlrev_b32 v15, 3, v31
    v_lshl_add_u32 v15, v29, 1, v15
    s_mul_i32 s48, s3, 144
    s_add_u32 s48, s48, 152000
    v_add_u32 v15, s48, v15
    v_mul_u32_u24 v20, 144, v30
    v_lshl_add_u32 v20, v29, 4, v20
    v_add_u32 v20, 152000, v20
    v_lshlrev_b32 v32, 2, v1
    v_add_u32 v32, 149312, v32
    ds_write_b32 v32, v50
    ds_write_b32 v32, v50 offset:1344
    s_lshl_b32 s48, s3, 12
    s_add_u32 s48, s48, 131072
    v_add_u32 v36, s48, v35
    s_waitcnt vmcnt(26)
    ds_write_b128 v36, v[240:243] offset:0
    ds_write_b128 v36, v[244:247] offset:1024
    ds_write_b128 v36, v[248:251] offset:2048
    ds_write_b128 v36, v[252:255] offset:3072
    v_lshrrev_b32 v28, 4, v1
    v_and_b32 v28, 1, v28
    v_mul_u32_u24 v29, 576, v28
    v_lshl_add_u32 v29, v31, 3, v29
    s_mul_i32 s48, s3, 144
    s_add_u32 s48, s48, 152000
    v_add_u32 v29, s48, v29
    v_lshlrev_b32 v30, 9, v28
    v_lshl_add_u32 v30, v31, 3, v30
    s_lshl_b32 s48, s3, 7
    s_add_u32 s48, s48, 154304
    v_add_u32 v30, s48, v30
    v_add_u32 v32, 1152, v29
    v_mov_b32 v34, 0
    s_cmp_eq_u32 s3, 0
    s_cselect_b32 s48, 0x3f803f80, 0
    v_mov_b32 v35, s48
    v_cmp_eq_u32 vcc, 0, v28
    s_nop 1
    v_cndmask_b32 v34, v34, v35, vcc
    v_mov_b32 v35, v34
    s_mov_b32 exec_hi, 0
    ds_write_b64 v29, v[26:27]
    ds_write_b64 v30, v[26:27]
    ds_write_b64 v32, v[34:35]
    s_mov_b64 exec, -1
    v_lshlrev_b32 v38, 16, v26
    v_and_b32 v39, 0xffff0000, v26
    v_lshlrev_b32 v40, 16, v27
    v_and_b32 v41, 0xffff0000, v27
    s_waitcnt lgkmcnt(0)
    s_barrier
    v_lshrrev_b32 v22, 4, v1
    v_lshlrev_b32 v22, 11, v22
    v_bfe_u32 v23, v1, 2, 2
    v_lshl_add_u32 v22, v23, 8, v22
    v_and_b32 v23, 3, v1
    v_lshl_add_u32 v22, v23, 3, v22
    s_lshl_b32 s49, s3, 6
    s_add_u32 s49, s49, 131072
    v_add_u32 v22, s49, v22
    ds_read_b64_tr_b16 a[208:209], v22 offset:0
    ds_read_b64_tr_b16 a[210:211], v22 offset:1024
    ds_read_b64_tr_b16 a[212:213], v22 offset:8192
    ds_read_b64_tr_b16 a[214:215], v22 offset:9216
    ds_read_b64_tr_b16 a[216:217], v22 offset:32
    ds_read_b64_tr_b16 a[218:219], v22 offset:1056
    ds_read_b64_tr_b16 a[220:221], v22 offset:8224
    ds_read_b64_tr_b16 a[222:223], v22 offset:9248
    v_add_f32 v42, v38, v39
    v_mul_f32 v43, v38, v38
    v_add_f32 v42, v42, v40
    v_fmac_f32 v43, v39, v39
    v_add_f32 v42, v42, v41
    v_fmac_f32 v43, v40, v40
    v_fmac_f32 v43, v41, v41
    s_nop 0
    v_add_f32_dpp v42, v42, v42 quad_perm:[1,0,3,2] row_mask:0xf bank_mask:0xf
    v_add_f32_dpp v43, v43, v43 quad_perm:[1,0,3,2] row_mask:0xf bank_mask:0xf
    s_nop 0
    v_add_f32_dpp v42, v42, v42 quad_perm:[2,3,0,1] row_mask:0xf bank_mask:0xf
    v_add_f32_dpp v43, v43, v43 quad_perm:[2,3,0,1] row_mask:0xf bank_mask:0xf
    s_nop 0
    v_add_f32_dpp v42, v42, v42 row_ror:4 row_mask:0xf bank_mask:0xf
    v_add_f32_dpp v43, v43, v43 row_ror:4 row_mask:0xf bank_mask:0xf
    s_nop 0
    v_add_f32_dpp v42, v42, v42 row_ror:8 row_mask:0xf bank_mask:0xf
    v_add_f32_dpp v43, v43, v43 row_ror:8 row_mask:0xf bank_mask:0xf
    v_and_or_b32 v42, v42, -2, 0
    v_and_or_b32 v43, v43, -2, 0
    v_and_b32 v44, 15, v1
    v_mul_u32_u24 v45, 144, v44
    v_lshrrev_b32 v23, 4, v1
    v_lshl_add_u32 v45, v23, 4, v45
    v_add_u32 v45, 152000, v45
    ds_read_b128 v[46:49], v45
    ds_read_b128 v[50:53], v45 offset:64
    s_waitcnt lgkmcnt(0)
    v_mfma_f32_16x16x32_bf16 v[54:57], a[208:211], v[46:49], 0
    v_mfma_f32_16x16x32_bf16 v[54:57], a[212:215], v[50:53], v[54:57]
    v_mfma_f32_16x16x32_bf16 v[58:61], a[216:219], v[46:49], 0
    v_mfma_f32_16x16x32_bf16 v[58:61], a[220:223], v[50:53], v[58:61]
    v_lshrrev_b32 v24, 2, v44
    v_lshlrev_b32 v24, 20, v24
    v_add_u32 v24, v24, v7
    v_add_u32 v24, 8126464, v24
    s_lshl_b32 s48, s4, 14
    s_lshl_b32 s49, s52, 12
    s_add_u32 s48, s48, s49
    s_lshl_b32 s49, s53, 9
    s_add_u32 s48, s48, s49
    s_lshl_b32 s49, s3, 7
    s_add_u32 s48, s48, s49
    s_add_u32 s48, s48, 11534336
    v_lshlrev_b32 v25, 4, v23
    v_add_u32 v25, s48, v25
    v_cmp_eq_u32 vcc, 8, v44
    s_nop 1
    v_cndmask_b32 v24, v24, v25, vcc
    v_cmp_gt_u32 vcc, 9, v44
    v_and_or_b32 v54, v54, -2, 0
    v_and_or_b32 v58, v58, -2, 0
    s_mov_b64 exec, vcc
    global_store_dwordx4 v24, v[54:57], s[6:7] sc1
    global_store_dwordx4 v24, v[58:61], s[6:7] offset:64 sc1
    s_mov_b64 exec, -1
    s_add_u32 s48, s38, 8126464
    v_lshlrev_b32 v26, 20, v23
    v_add_u32 v26, s48, v26
    s_mov_b32 exec_lo, 0x00010001
    s_mov_b32 exec_hi, 0
    global_store_dwordx2 v26, v[42:43], s[6:7] sc1
    s_mov_b64 exec, -1
    s_cmp_ge_u32 s24, s25
    s_cbranch_scc1 Lpk_15
    s_mov_b32 m0, s26
    s_add_u32 s0, s16, s101
    s_addc_u32 s1, s17, 0
    s_add_u32 s24, s24, 2
    global_load_lds_dwordx4 v8, s[0:1] nt
    global_load_lds_dwordx4 v9, s[0:1] offset:1024 nt
    s_add_u32 s101, s101, 65536
    s_and_b32 s101, s101, 0x7ffff
    s_add_u32 s26, s26, 2048
    s_and_b32 s0, s24, 15
    s_cbranch_scc0 Lps_16
Lpk_15:
    s_cmp_ge_u32 s24, s25
    s_cbranch_scc1 Lpk_17
    s_mov_b32 m0, s26
    s_add_u32 s0, s16, s101
    s_addc_u32 s1, s17, 0
    s_add_u32 s24, s24, 2
    global_load_lds_dwordx4 v8, s[0:1] nt
    global_load_lds_dwordx4 v9, s[0:1] offset:1024 nt
    s_add_u32 s101, s101, 65536
    s_and_b32 s101, s101, 0x7ffff
    s_add_u32 s26, s26, 2048
    s_and_b32 s0, s24, 15
    s_cbranch_scc0 Lps_18
Lpk_17:
    s_waitcnt vmcnt(9)
    s_barrier
    ds_write_b128 v36, v[192:195] offset:0
    ds_write_b128 v36, v[196:199] offset:1024
    ds_write_b128 v36, v[200:203] offset:2048
    ds_write_b128 v36, v[204:207] offset:3072
    s_waitcnt lgkmcnt(0)
    s_barrier
    v_lshrrev_b32 v22, 4, v1
    v_lshlrev_b32 v22, 11, v22
    v_bfe_u32 v23, v1, 2, 2
    v_lshl_add_u32 v22, v23, 8, v22
    v_and_b32 v23, 3, v1
    v_lshl_add_u32 v22, v23, 3, v22
    s_lshl_b32 s49, s3, 6
    s_add_u32 s49, s49, 131072
    v_add_u32 v22, s49, v22
    ds_read_b64_tr_b16 a[240:241], v22 offset:0
    ds_read_b64_tr_b16 a[242:243], v22 offset:1024
    ds_read_b64_tr_b16 a[244:245], v22 offset:8192
    ds_read_b64_tr_b16 a[246:247], v22 offset:9216
    ds_read_b64_tr_b16 a[248:249], v22 offset:32
    ds_read_b64_tr_b16 a[250:251], v22 offset:1056
    ds_read_b64_tr_b16 a[252:253], v22 offset:8224
    ds_read_b64_tr_b16 a[254:255], v22 offset:9248
    s_cmp_ge_u32 s24, s25
    s_cbranch_scc1 Lpk_19
    s_mov_b32 m0, s26
    s_add_u32 s0, s16, s101
    s_addc_u32 s1, s17, 0
    s_add_u32 s24, s24, 2
    global_load_lds_dwordx4 v8, s[0:1] nt
    global_load_lds_dwordx4 v9, s[0:1] offset:1024 nt
    s_add_u32 s101, s101, 65536
    s_and_b32 s101, s101, 0x7ffff
    s_add_u32 s26, s26, 2048
    s_and_b32 s0, s24, 15
    s_cbranch_scc0 Lps_20
Lpk_19:
    s_cmp_ge_u32 s24, s25
    s_cbranch_scc1 Lpk_21
    s_mov_b32 m0, s26
    s_add_u32 s0, s16, s101
    s_addc_u32 s1, s17, 0
    s_add_u32 s24, s24, 2
    global_load_lds_dwordx4 v8, s[0:1] nt
    global_load_lds_dwordx4 v9, s[0:1] offset:1024 nt
    s_add_u32 s101, s101, 65536
    s_and_b32 s101, s101, 0x7ffff
    s_add_u32 s26, s26, 2048
    s_and_b32 s0, s24, 15
    s_cbranch_scc0 Lps_22
Lpk_21:
    s_waitcnt lgkmcnt(0)
    s_barrier
    ds_write_b128 v36, v[208:211] offset:0
    ds_write_b128 v36, v[212:215] offset:1024
    ds_write_b128 v36, v[216:219] offset:2048
    ds_write_b128 v36, v[220:223] offset:3072
    v_mfma_f32_16x16x32_bf16 v[54:57], a[240:243], v[46:49], 0
    v_mfma_f32_16x16x32_bf16 v[54:57], a[244:247], v[50:53], v[54:57]
    v_mfma_f32_16x16x32_bf16 v[58:61], a[248:251], v[46:49], 0
    v_mfma_f32_16x16x32_bf16 v[58:61], a[252:255], v[50:53], v[58:61]
    s_waitcnt vmcnt(8) lgkmcnt(0)
    s_barrier
    s_cmp_lg_u32 s3, 0
    s_cbranch_scc1 L_arr_done
    s_getreg_b32 s48, hwreg(HW_REG_XCC_ID, 0, 3)
    s_mul_i32 s48, s48, 3
    s_lshl_b32 s48, 1, s48
    s_or_b32 s48, s48, 0x10000000
    s_lshl_b32 s49, s4, 5
    s_lshl_b32 s50, s53, 2
    s_add_u32 s49, s49, s50
    v_mov_b32 v30, s48
    v_mov_b32 v31, s49
    s_mov_b64 exec, 1
    global_atomic_add v31, v30, s[10:11] sc1
    s_mov_b64 exec, -1
L_arr_done:
    v_lshrrev_b32 v22, 4, v1
    v_lshlrev_b32 v22, 10, v22
    v_bfe_u32 v23, v1, 2, 2
    v_lshl_add_u32 v22, v23, 7, v22
    v_and_b32 v23, 3, v1
    v_lshl_add_u32 v22, v23, 3, v22
    s_lshl_b32 s49, s3, 5
    s_add_u32 s49, s49, 131072
    v_add_u32 v22, s49, v22
    ds_read_b64_tr_b16 a[192:193], v22 offset:0
    ds_read_b64_tr_b16 a[194:195], v22 offset:512
    ds_read_b64_tr_b16 a[196:197], v22 offset:4096
    ds_read_b64_tr_b16 a[198:199], v22 offset:4608
    ds_read_b64_tr_b16 a[200:201], v22 offset:8192
    ds_read_b64_tr_b16 a[202:203], v22 offset:8704
    ds_read_b64_tr_b16 a[204:205], v22 offset:12288
    ds_read_b64_tr_b16 a[206:207], v22 offset:12800
    v_add_u32 v25, 131072, v25
    v_cmp_eq_u32 vcc, 8, v44
    s_mov_b64 exec, vcc
    global_store_dwordx4 v25, v[54:57], s[6:7] sc1
    global_store_dwordx4 v25, v[58:61], s[6:7] offset:64 sc1
    s_mov_b64 exec, -1
    s_cmp_ge_u32 s24, s25
    s_cbranch_scc1 Lpk_23
    s_getreg_b32 s0, hwreg(HW_REG_IB_STS)
    s_and_b32 s0, s0, 0xc0000f
    s_cmp_gt_u32 s0, s54
    s_cbranch_scc1 Lpk_23
    s_mov_b32 m0, s26
    s_add_u32 s0, s16, s101
    s_addc_u32 s1, s17, 0
    s_add_u32 s24, s24, 2
    global_load_lds_dwordx4 v8, s[0:1] nt
    global_load_lds_dwordx4 v9, s[0:1] offset:1024 nt
    s_add_u32 s101, s101, 65536
    s_and_b32 s101, s101, 0x7ffff
    s_add_u32 s26, s26, 2048
    s_and_b32 s0, s24, 15
    s_cbranch_scc0 Lps_24
Lpk_23:
    s_cmp_ge_u32 s24, s25
    s_cbranch_scc1 Lpk_25
    s_getreg_b32 s0, hwreg(HW_REG_IB_STS)
    s_and_b32 s0, s0, 0xc0000f
    s_cmp_gt_u32 s0, s54
    s_cbranch_scc1 Lpk_25
    s_mov_b32 m0, s26
    s_add_u32 s0, s16, s101
    s_addc_u32 s1, s17, 0
    s_add_u32 s24, s24, 2
    global_load_lds_dwordx4 v8, s[0:1] nt
    global_load_lds_dwordx4 v9, s[0:1] offset:1024 nt
    s_add_u32 s101, s101, 65536
    s_and_b32 s101, s101, 0x7ffff
    s_add_u32 s26, s26, 2048
    s_and_b32 s0, s24, 15
    s_cbranch_scc0 Lps_26
Lpk_25:
    s_waitcnt lgkmcnt(0)
    s_barrier
    ds_write_b128 v36, v[224:227] offset:0
    ds_write_b128 v36, v[228:231] offset:1024
    ds_write_b128 v36, v[232:235] offset:2048
    ds_write_b128 v36, v[236:239] offset:3072
    s_waitcnt lgkmcnt(0)
    s_barrier
    v_lshrrev_b32 v22, 4, v1
    v_lshlrev_b32 v22, 10, v22
    v_bfe_u32 v23, v1, 2, 2
    v_lshl_add_u32 v22, v23, 7, v22
    v_and_b32 v23, 3, v1
    v_lshl_add_u32 v22, v23, 3, v22
    s_lshl_b32 s49, s3, 5
    s_add_u32 s49, s49, 131072
    v_add_u32 v22, s49, v22
    ds_read_b64_tr_b16 a[224:225], v22 offset:0
    ds_read_b64_tr_b16 a[226:227], v22 offset:512
    ds_read_b64_tr_b16 a[228:229], v22 offset:4096
    ds_read_b64_tr_b16 a[230:231], v22 offset:4608
    ds_read_b64_tr_b16 a[232:233], v22 offset:8192
    ds_read_b64_tr_b16 a[234:235], v22 offset:8704
    ds_read_b64_tr_b16 a[236:237], v22 offset:12288
    ds_read_b64_tr_b16 a[238:239], v22 offset:12800
    s_cmp_ge_u32 s24, s25
    s_cbranch_scc1 Lpk_27
    s_getreg_b32 s0, hwreg(HW_REG_IB_STS)
    s_and_b32 s0, s0, 0xc0000f
    s_cmp_gt_u32 s0, s54
    s_cbranch_scc1 Lpk_27
    s_mov_b32 m0, s26
    s_add_u32 s0, s16, s101
    s_addc_u32 s1, s17, 0
    s_add_u32 s24, s24, 2
    global_load_lds_dwordx4 v8, s[0:1] nt
    global_load_lds_dwordx4 v9, s[0:1] offset:1024 nt
    s_add_u32 s101, s101, 65536
    s_and_b32 s101, s101, 0x7ffff
    s_add_u32 s26, s26, 2048
    s_and_b32 s0, s24, 15
    s_cbranch_scc0 Lps_28
Lpk_27:
    s_cmp_ge_u32 s24, s25
    s_cbranch_scc1 Lpk_29
    s_getreg_b32 s0, hwreg(HW_REG_IB_STS)
    s_and_b32 s0, s0, 0xc0000f
    s_cmp_gt_u32 s0, s54
    s_cbranch_scc1 Lpk_29
    s_mov_b32 m0, s26
    s_add_u32 s0, s16, s101
    s_addc_u32 s1, s17, 0
    s_add_u32 s24, s24, 2
    global_load_lds_dwordx4 v8, s[0:1] nt
    global_load_lds_dwordx4 v9, s[0:1] offset:1024 nt
    s_add_u32 s101, s101, 65536
    s_and_b32 s101, s101, 0x7ffff
    s_add_u32 s26, s26, 2048
    s_and_b32 s0, s24, 15
    s_cbranch_scc0 Lps_30
Lpk_29:
    s_waitcnt lgkmcnt(0)
    s_barrier
    s_xor_b32 s48, s3, 1
    s_or_b32 s48, s5, s48
    s_cmp_lg_u32 s48, 0
    s_cbranch_scc1 L_notlead
    s_lshl_b32 s48, s4, 5
    s_add_u32 s44, s10, s48
    s_addc_u32 s45, s11, 0
L_team:
    s_add_u32 s31, s31, 1
    s_cmp_gt_u32 s31, 1000000
    s_cbranch_scc1 L_done
    s_load_dwordx8 s[72:79], s[44:45], 0 glc
    s_cmp_ge_u32 s24, s25
    s_cbranch_scc1 Lpk_31
    s_getreg_b32 s0, hwreg(HW_REG_IB_STS)
    s_and_b32 s0, s0, 0xc0000f
    s_cmp_gt_u32 s0, s54
    s_cbranch_scc1 Lpk_31
    s_mov_b32 m0, s26
    s_add_u32 s0, s16, s101
    s_addc_u32 s1, s17, 0
    s_add_u32 s24, s24, 2
    global_load_lds_dwordx4 v8, s[0:1] nt
    global_load_lds_dwordx4 v9, s[0:1] offset:1024 nt
    s_add_u32 s101, s101, 65536
    s_and_b32 s101, s101, 0x7ffff
    s_add_u32 s26, s26, 2048
    s_and_b32 s0, s24, 15
    s_cbranch_scc0 Lps_32
Lpk_31:
    s_cmp_ge_u32 s24, s25
    s_cbranch_scc1 Lpk_33
    s_getreg_b32 s0, hwreg(HW_REG_IB_STS)
    s_and_b32 s0, s0, 0xc0000f
    s_cmp_gt_u32 s0, s54
    s_cbranch_scc1 Lpk_33
    s_mov_b32 m0, s26
    s_add_u32 s0, s16, s101
    s_addc_u32 s1, s17, 0
    s_add_u32 s24, s24, 2
    global_load_lds_dwordx4 v8, s[0:1] nt
    global_load_lds_dwordx4 v9, s[0:1] offset:1024 nt
    s_add_u32 s101, s101, 65536
    s_and_b32 s101, s101, 0x7ffff
    s_add_u32 s26, s26, 2048
    s_and_b32 s0, s24, 15
    s_cbranch_scc0 Lps_34
Lpk_33:
    s_waitcnt lgkmcnt(0)
    s_and_b32 s0, s72, s73
    s_or_b32 s1, s72, s73
    s_and_b32 s0, s0, s74
    s_or_b32 s1, s1, s74
    s_and_b32 s0, s0, s75
    s_or_b32 s1, s1, s75
    s_and_b32 s0, s0, s76
    s_or_b32 s1, s1, s76
    s_and_b32 s0, s0, s77
    s_or_b32 s1, s1, s77
    s_and_b32 s0, s0, s78
    s_or_b32 s1, s1, s78
    s_and_b32 s0, s0, s79
    s_or_b32 s1, s1, s79
    s_bitcmp0_b32 s0, 30
    s_cbranch_scc1 L_team
    s_bcnt1_i32_b32 s48, s1
    s_xor_b32 s48, s48, 2
    s_xor_b32 s1, s1, s0
    s_or_b32 s48, s48, s1
    s_cmp_eq_u32 s48, 0
    s_cselect_b32 s48, 1, 0
    v_mov_b32 v54, s48
    v_lshlrev_b32 v55, 10, v1
    v_add_u32 v55, s40, v55
    s_mov_b32 exec_hi, 0
    global_store_dword v55, v54, s[6:7] sc1
    s_mov_b64 exec, -1
L_notlead:
    s_add_u32 s44, s6, s40
    s_addc_u32 s45, s7, 0
L_go:
    s_add_u32 s31, s31, 1
    s_cmp_gt_u32 s31, 1000000
    s_cbranch_scc1 L_done
    s_load_dword s30, s[44:45], 0 glc
    s_cmp_ge_u32 s24, s25
    s_cbranch_scc1 Lpk_35
    s_getreg_b32 s0, hwreg(HW_REG_IB_STS)
    s_and_b32 s0, s0, 0xc0000f
    s_cmp_gt_u32 s0, s54
    s_cbranch_scc1 Lpk_35
    s_mov_b32 m0, s26
    s_add_u32 s0, s16, s101
    s_addc_u32 s1, s17, 0
    s_add_u32 s24, s24, 2
    global_load_lds_dwordx4 v8, s[0:1] nt
    global_load_lds_dwordx4 v9, s[0:1] offset:1024 nt
    s_add_u32 s101, s101, 65536
    s_and_b32 s101, s101, 0x7ffff
    s_add_u32 s26, s26, 2048
    s_and_b32 s0, s24, 15
    s_cbranch_scc0 Lps_36
Lpk_35:
    s_cmp_ge_u32 s24, s25
    s_cbranch_scc1 Lpk_37
    s_getreg_b32 s0, hwreg(HW_REG_IB_STS)
    s_and_b32 s0, s0, 0xc0000f
    s_cmp_gt_u32 s0, s54
    s_cbranch_scc1 Lpk_37
    s_mov_b32 m0, s26
    s_add_u32 s0, s16, s101
    s_addc_u32 s1, s17, 0
    s_add_u32 s24, s24, 2
    global_load_lds_dwordx4 v8, s[0:1] nt
    global_load_lds_dwordx4 v9, s[0:1] offset:1024 nt
    s_add_u32 s101, s101, 65536
    s_and_b32 s101, s101, 0x7ffff
    s_add_u32 s26, s26, 2048
    s_and_b32 s0, s24, 15
    s_cbranch_scc0 Lps_38
Lpk_37:
    s_call_b64 s[62:63], L_service
    s_cmp_eq_u32 s30, -1
    s_cbranch_scc1 L_go
    s_mov_b32 s39, 12
    s_mov_b32 s43, 0
    s_mov_b32 s50, 148224
    s_mov_b32 s94, 0
    s_add_u32 s14, s6, 9437184
    s_addc_u32 s15, s7, 0
    s_mov_b32 s88, 1
    s_call_b64 s[92:93], L_stq
    s_xor_b32 s48, s3, 1
    s_or_b32 s48, s5, s48
    s_cmp_lg_u32 s48, 0
    s_cbranch_scc1 L_notlead2
L_all:
    s_add_u32 s31, s31, 1
    s_cmp_gt_u32 s31, 1000000
    s_cbranch_scc1 L_done
    s_load_dwordx16 s[64:79], s[10:11], 0 glc
    s_cmp_ge_u32 s24, s25
    s_cbranch_scc1 Lpk_39
    s_getreg_b32 s0, hwreg(HW_REG_IB_STS)
    s_and_b32 s0, s0, 0xc0000f
    s_cmp_gt_u32 s0, s54
    s_cbranch_scc1 Lpk_39
    s_mov_b32 m0, s26
    s_add_u32 s0, s16, s101
    s_addc_u32 s1, s17, 0
    s_add_u32 s24, s24, 2
    global_load_lds_dwordx4 v8, s[0:1] nt
    global_load_lds_dwordx4 v9, s[0:1] offset:1024 nt
    s_add_u32 s101, s101, 65536
    s_and_b32 s101, s101, 0x7ffff
    s_add_u32 s26, s26, 2048
    s_and_b32 s0, s24, 15
    s_cbranch_scc0 Lps_40
Lpk_39:
    s_waitcnt lgkmcnt(0)
    s_and_b64 s[0:1], s[64:65], s[66:67]
    s_and_b64 s[0:1], s[0:1], s[68:69]
    s_and_b64 s[0:1], s[0:1], s[70:71]
    s_and_b64 s[0:1], s[0:1], s[72:73]
    s_and_b64 s[0:1], s[0:1], s[74:75]
    s_and_b64 s[0:1], s[0:1], s[76:77]
    s_and_b64 s[0:1], s[0:1], s[78:79]
    s_and_b32 s0, s0, s1
    s_bitcmp0_b32 s0, 30
    s_cbranch_scc1 L_all
    s_load_dwordx16 s[64:79], s[10:11], 64 glc
    s_cmp_ge_u32 s24, s25
    s_cbranch_scc1 Lpk_41
    s_getreg_b32 s0, hwreg(HW_REG_IB_STS)
    s_and_b32 s0, s0, 0xc0000f
    s_cmp_gt_u32 s0, s54
    s_cbranch_scc1 Lpk_41
    s_mov_b32 m0, s26
    s_add_u32 s0, s16, s101
    s_addc_u32 s1, s17, 0
    s_add_u32 s24, s24, 2
    global_load_lds_dwordx4 v8, s[0:1] nt
    global_load_lds_dwordx4 v9, s[0:1] offset:1024 nt
    s_add_u32 s101, s101, 65536
    s_and_b32 s101, s101, 0x7ffff
    s_add_u32 s26, s26, 2048
    s_and_b32 s0, s24, 15
    s_cbranch_scc0 Lps_42
Lpk_41:
    s_waitcnt lgkmcnt(0)
    s_and_b64 s[0:1], s[64:65], s[66:67]
    s_and_b64 s[0:1], s[0:1], s[68:69]
    s_and_b64 s[0:1], s[0:1], s[70:71]
    s_and_b64 s[0:1], s[0:1], s[72:73]
    s_and_b64 s[0:1], s[0:1], s[74:75]
    s_and_b64 s[0:1], s[0:1], s[76:77]
    s_and_b64 s[0:1], s[0:1], s[78:79]
    s_and_b32 s0, s0, s1
    s_bitcmp0_b32 s0, 30
    s_cbranch_scc1 L_all
    s_load_dwordx16 s[64:79], s[10:11], 128 glc
    s_cmp_ge_u32 s24, s25
    s_cbranch_scc1 Lpk_43
    s_getreg_b32 s0, hwreg(HW_REG_IB_STS)
    s_and_b32 s0, s0, 0xc0000f
    s_cmp_gt_u32 s0, s54
    s_cbranch_scc1 Lpk_43
    s_mov_b32 m0, s26
    s_add_u32 s0, s16, s101
    s_addc_u32 s1, s17, 0
    s_add_u32 s24, s24, 2
    global_load_lds_dwordx4 v8, s[0:1] nt
    global_load_lds_dwordx4 v9, s[0:1] offset:1024 nt
    s_add_u32 s101, s101, 65536
    s_and_b32 s101, s101, 0x7ffff
    s_add_u32 s26, s26, 2048
    s_and_b32 s0, s24, 15
    s_cbranch_scc0 Lps_44
Lpk_43:
    s_waitcnt lgkmcnt(0)
    s_and_b64 s[0:1], s[64:65], s[66:67]
    s_and_b64 s[0:1], s[0:1], s[68:69]
    s_and_b64 s[0:1], s[0:1], s[70:71]
    s_and_b64 s[0:1], s[0:1], s[72:73]
    s_and_b64 s[0:1], s[0:1], s[74:75]
    s_and_b64 s[0:1], s[0:1], s[76:77]
    s_and_b64 s[0:1], s[0:1], s[78:79]
    s_and_b32 s0, s0, s1
    s_bitcmp0_b32 s0, 30
    s_cbranch_scc1 L_all
    s_load_dwordx16 s[64:79], s[10:11], 192 glc
    s_cmp_ge_u32 s24, s25
    s_cbranch_scc1 Lpk_45
    s_getreg_b32 s0, hwreg(HW_REG_IB_STS)
    s_and_b32 s0, s0, 0xc0000f
    s_cmp_gt_u32 s0, s54
    s_cbranch_scc1 Lpk_45
    s_mov_b32 m0, s26
    s_add_u32 s0, s16, s101
    s_addc_u32 s1, s17, 0
    s_add_u32 s24, s24, 2
    global_load_lds_dwordx4 v8, s[0:1] nt
    global_load_lds_dwordx4 v9, s[0:1] offset:1024 nt
    s_add_u32 s101, s101, 65536
    s_and_b32 s101, s101, 0x7ffff
    s_add_u32 s26, s26, 2048
    s_and_b32 s0, s24, 15
    s_cbranch_scc0 Lps_46
Lpk_45:
    s_waitcnt lgkmcnt(0)
    s_and_b64 s[0:1], s[64:65], s[66:67]
    s_and_b64 s[0:1], s[0:1], s[68:69]
    s_and_b64 s[0:1], s[0:1], s[70:71]
    s_and_b64 s[0:1], s[0:1], s[72:73]
    s_and_b64 s[0:1], s[0:1], s[74:75]
    s_and_b64 s[0:1], s[0:1], s[76:77]
    s_and_b64 s[0:1], s[0:1], s[78:79]
    s_and_b32 s0, s0, s1
    s_bitcmp0_b32 s0, 30
    s_cbranch_scc1 L_all
    v_mov_b32 v54, 0
    v_lshlrev_b32 v55, 10, v1
    v_add_u32 v55, s40, v55
    s_mov_b32 exec_hi, 0
    global_store_dword v55, v54, s[6:7] offset:4 sc1
    s_mov_b64 exec, -1
L_notlead2:
    s_add_u32 s32, s6, 1048576
    s_addc_u32 s33, s7, 0
L_phase:
    s_bfe_u32 s42, s28, 0x10001
    s_sub_u32 s43, s28, 1
    s_bfe_u32 s43, s43, 0x10001
    s_and_b32 s39, s28, 1
    s_xor_b32 s49, s39, 1
    s_lshl_b32 s49, s49, 21
    s_add_u32 s49, s49, 2359296
    s_add_u32 s14, s6, s49
    s_addc_u32 s15, s7, 0
    s_lshr_b32 s48, s28, 2
    s_sub_u32 s48, s28, s48
    s_bfe_u32 s78, s48, 0x10001
    s_and_b32 s48, s48, 1
    s_lshl_b32 s48, s48, 21
    s_add_u32 s48, s48, 1048576
    s_add_u32 s76, s6, s48
    s_addc_u32 s77, s7, 0
    s_and_b32 s27, s28, 4
    s_lshl_b32 s49, s39, 1
    s_add_u32 s27, s27, s49
    s_mov_b32 s50, 148224
    s_bitcmp0_b32 s28, 1
    s_cbranch_scc1 L_first
    s_mov_b32 s94, 2
    s_cmp_eq_u32 s28, 3
    s_cbranch_scc1 L_e4
L_stq:
    s_and_b32 s48, s39, 1
    s_lshl_b32 s48, s48, 11
    s_lshl_b32 s49, s3, 9
    s_add_u32 s48, s48, s49
    s_add_u32 s48, s48, 155328
    v_lshl_add_u32 v57, v4, 1, s48
    ds_read_b64 v[58:59], v57
    s_mul_i32 s48, s3, 272
    s_add_u32 s48, s48, s50
    v_add_u32 v62, s48, v4
    s_add_u32 s46, s14, 4293664768
    s_addc_u32 s47, s15, -1
    s_mov_b32 s82, 16
    s_cmp_lt_u32 s24, s13
    s_cbranch_scc1 Ldl_47
Ldb_48:
    s_bitcmp1_b32 s39, 2
    s_cbranch_scc1 L_cs1
L_gC:
    s_add_u32 s31, s31, 1
    s_cmp_gt_u32 s31, 1000000
    s_cbranch_scc1 L_done
    global_load_dwordx2 v[54:55], v5, s[46:47] sc1
    global_load_dwordx4 v[22:25], v2, s[14:15] offset:0 sc1
    global_load_dwordx4 v[26:29], v2, s[14:15] offset:1024 sc1
    global_load_dwordx4 v[30:33], v2, s[14:15] offset:2048 sc1
    global_load_dwordx4 v[34:37], v2, s[14:15] offset:3072 sc1
    s_mov_b64 exec, -1
    s_cmp_lt_u32 s24, s13
    s_cbranch_scc1 Lgs_52
    s_mov_b32 s100, s24
    s_waitcnt vmcnt(0)
Lgd_51:
    s_cmp_lg_u32 s43, 0
    s_cbranch_scc1 Ltg_56
    v_bitop3_b32 v56, v22, v26, v30 bitop3:0xfe
    v_bitop3_b32 v56, v56, v34, v54 bitop3:0xfe
    v_bitop3_b32 v56, v56, v55, v55 bitop3:0xfe
Ltb_57:
    v_and_b32 v56, 1, v56
    v_cmp_ne_u32 vcc, s43, v56
    s_cbranch_vccnz Ltr_58
    s_bitcmp1_b32 s39, 2
    s_cbranch_scc1 L_cs2
L_cs2b:
    s_cmp_lt_u32 s24, s25
    s_cbranch_scc1 Lpo_59
Lpr_60:
    v_add_f32_dpp v56, v54, v54 quad_perm:[1,0,3,2] row_mask:0xf bank_mask:0xf
    v_pk_add_f32 v[22:23], v[22:23], v[26:27]
    v_pk_add_f32 v[24:25], v[24:25], v[28:29]
    v_add_f32_dpp v56, v56, v56 quad_perm:[2,3,0,1] row_mask:0xf bank_mask:0xf
    v_pk_add_f32 v[30:31], v[30:31], v[34:35]
    v_pk_add_f32 v[32:33], v[32:33], v[36:37]
    v_add_f32_dpp v56, v56, v56 row_half_mirror row_mask:0xf bank_mask:0xf
    v_pk_add_f32 v[22:23], v[22:23], v[30:31]
    v_pk_add_f32 v[24:25], v[24:25], v[32:33]
    v_mul_f32 v17, 0.001953125, v56
    v_mov_b32 v19, v55
    v_permlane32_swap_b32 v22, v24
    v_permlane32_swap_b32 v23, v25
    v_cvt_pk_bf16_f32 v56, 0, v17
    v_pk_add_f32 v[22:23], v[22:23], v[24:25]
    s_waitcnt lgkmcnt(0)
    v_pk_fma_f32 v[22:23], v[58:59], v[56:57], v[22:23] op_sel_hi:[1,0,1] neg_lo:[1,0,0] neg_hi:[1,0,0]
    v_cvt_pk_bf16_f32 v22, v22, v23
    ds_write_b32 v62, v22
    s_bitcmp1_b32 s39, 3
    s_cbranch_scc1 L_eF
L_eFb:
    s_waitcnt lgkmcnt(0)
    s_barrier
    s_cmp_lg_u32 s88, 0
    s_cbranch_scc1 L_stret
    s_bitcmp0_b32 s28, 1
    s_cbranch_scc1 L_seq1
L_m2:
    s_add_u32 s51, s27, 1
    s_cmp_le_u32 s35, s51
    s_cbranch_scc1 L_m2w
    ds_read_b128 v[22:25], v0 offset:0
    ds_read_b128 v[26:29], v0 offset:64
    ds_read_b128 v[30:33], v0 offset:128
    ds_read_b128 v[34:37], v0 offset:192
    v_mov_b32_dpp v62, v0 row_ror:4 row_mask:0xf bank_mask:0xf
    s_cmp_eq_u32 s27, 2
    s_cbranch_scc1 L_a2_2
    s_cmp_eq_u32 s27, 4
    s_cbranch_scc1 L_a2_1
    ds_read_b128 v[38:41], v62 offset:0
    ds_read_b128 v[42:45], v62 offset:64
    ds_read_b128 v[46:49], v62 offset:128
    ds_read_b128 v[50:53], v62 offset:192
    s_waitcnt lgkmcnt(7)
    v_mfma_f32_16x16x32_bf16 v[54:57], a[0:3], v[22:25], 0
    s_waitcnt lgkmcnt(6)
    v_mfma_f32_16x16x32_bf16 v[54:57], a[4:7], v[26:29], v[54:57]
    s_waitcnt lgkmcnt(5)
    v_mfma_f32_16x16x32_bf16 v[54:57], a[8:11], v[30:33], v[54:57]
    s_waitcnt lgkmcnt(4)
    v_mfma_f32_16x16x32_bf16 v[54:57], a[12:15], v[34:37], v[54:57]
    v_mov_b32_dpp v62, v0 row_ror:8 row_mask:0xf bank_mask:0xf
    v_mfma_f32_16x16x32_bf16 v[58:61], a[64:67], v[22:25], 0
    ds_read_b128 v[22:25], v62 offset:0
    v_mfma_f32_16x16x32_bf16 v[58:61], a[68:71], v[26:29], v[58:61]
    ds_read_b128 v[26:29], v62 offset:64
    v_mfma_f32_16x16x32_bf16 v[58:61], a[72:75], v[30:33], v[58:61]
    ds_read_b128 v[30:33], v62 offset:128
    v_mfma_f32_16x16x32_bf16 v[58:61], a[76:79], v[34:37], v[58:61]
    ds_read_b128 v[34:37], v62 offset:192
    s_waitcnt lgkmcnt(4)
    v_mfma_f32_16x16x32_bf16 v[54:57], a[16:19], v[38:41], v[54:57]
    v_add_f32_dpp v19, v19, v19 quad_perm:[1,0,3,2] row_mask:0xf bank_mask:0xf
    v_mfma_f32_16x16x32_bf16 v[54:57], a[20:23], v[42:45], v[54:57]
    v_mul_f32 v21, v17, v17
    v_mfma_f32_16x16x32_bf16 v[54:57], a[24:27], v[46:49], v[54:57]
    s_nop 0
    v_add_f32_dpp v19, v19, v19 quad_perm:[2,3,0,1] row_mask:0xf bank_mask:0xf
    v_mfma_f32_16x16x32_bf16 v[54:57], a[28:31], v[50:53], v[54:57]
    v_mov_b32_dpp v62, v0 row_ror:12 row_mask:0xf bank_mask:0xf
    v_mfma_f32_16x16x32_bf16 v[58:61], a[80:83], v[38:41], v[58:61]
    ds_read_b128 v[38:41], v62 offset:0
    v_mfma_f32_16x16x32_bf16 v[58:61], a[84:87], v[42:45], v[58:61]
    ds_read_b128 v[42:45], v62 offset:64
    v_mfma_f32_16x16x32_bf16 v[58:61], a[88:91], v[46:49], v[58:61]
    ds_read_b128 v[46:49], v62 offset:128
    v_mfma_f32_16x16x32_bf16 v[58:61], a[92:95], v[50:53], v[58:61]
    ds_read_b128 v[50:53], v62 offset:192
    s_waitcnt lgkmcnt(4)
    v_mfma_f32_16x16x32_bf16 v[54:57], a[32:35], v[22:25], v[54:57]
    s_nop 1
    v_add_f32_dpp v19, v19, v19 row_half_mirror row_mask:0xf bank_mask:0xf
    v_mfma_f32_16x16x32_bf16 v[54:57], a[36:39], v[26:29], v[54:57]
    v_mul_f32 v19, 0.001953125, v19
    v_mfma_f32_16x16x32_bf16 v[54:57], a[40:43], v[30:33], v[54:57]
    v_sub_f32 v19, v19, v21
    v_mfma_f32_16x16x32_bf16 v[54:57], a[44:47], v[34:37], v[54:57]
    v_max_f32 v19, 0, v19
    v_mfma_f32_16x16x32_bf16 v[58:61], a[96:99], v[22:25], v[58:61]
    v_cvt_pk_bf16_f32 v19, 0, v19
    v_mfma_f32_16x16x32_bf16 v[58:61], a[100:103], v[26:29], v[58:61]
    v_add_f32 v19, 0x3727c5ac, v19
    v_mfma_f32_16x16x32_bf16 v[58:61], a[104:107], v[30:33], v[58:61]
    v_cvt_pk_bf16_f32 v19, 0, v19
    v_mfma_f32_16x16x32_bf16 v[58:61], a[108:111], v[34:37], v[58:61]
    v_sqrt_f32 v19, v19
    s_waitcnt lgkmcnt(0)
    v_mfma_f32_16x16x32_bf16 v[54:57], a[48:51], v[38:41], v[54:57]
    s_nop 0
    v_cvt_pk_bf16_f32 v19, 0, v19
    v_mfma_f32_16x16x32_bf16 v[54:57], a[52:55], v[42:45], v[54:57]
    v_rcp_f32 v19, v19
    v_mfma_f32_16x16x32_bf16 v[54:57], a[56:59], v[46:49], v[54:57]
    s_nop 0
    v_mul_f32 v17, s57, v19
    v_mfma_f32_16x16x32_bf16 v[54:57], a[60:63], v[50:53], v[54:57]
    v_mfma_f32_16x16x32_bf16 v[58:61], a[112:115], v[38:41], v[58:61]
    v_mfma_f32_16x16x32_bf16 v[58:61], a[116:119], v[42:45], v[58:61]
    v_mfma_f32_16x16x32_bf16 v[58:61], a[120:123], v[46:49], v[58:61]
    v_mfma_f32_16x16x32_bf16 v[58:61], a[124:127], v[50:53], v[58:61]
    s_cmp_eq_u32 s28, 2
    s_cbranch_scc1 L_ek
L_ekb:
    s_cmp_lt_u32 s24, s25
    s_cbranch_scc1 Lpo_69
Lpr_70:
    s_lshl_b32 s49, s3, 2
    s_add_u32 s49, s49, 147968
    s_nop 1
    v_max3_f32 v62, v54, v55, v56
    s_nop 2
    v_max3_f32 v21, v58, v59, v60
    v_max3_f32 v62, v62, v57, v61
    v_max_f32 v62, v62, v21
    s_nop 1
    v_max_f32_dpp v62, v62, v62 row_ror:4 row_mask:0xf bank_mask:0xf
    s_nop 1
    v_max_f32_dpp v62, v62, v62 row_ror:8 row_mask:0xf bank_mask:0xf
    v_mov_b32 v21, v62
    s_nop 1
    v_permlane32_swap_b32 v62, v21
    s_nop 0
    v_max_f32 v62, v62, v21
    v_mov_b32 v21, v62
    s_nop 1
    v_permlane16_swap_b32 v62, v21
    s_nop 0
    v_max_f32 v62, v62, v21
    v_mul_f32 v62, v17, v62
    v_pk_fma_f32 v[54:55], v[54:55], v[16:17], v[62:63] op_sel:[0,1,0] op_sel_hi:[1,1,0] neg_lo:[0,0,1] neg_hi:[0,0,1]
    v_pk_fma_f32 v[56:57], v[56:57], v[16:17], v[62:63] op_sel:[0,1,0] op_sel_hi:[1,1,0] neg_lo:[0,0,1] neg_hi:[0,0,1]
    v_pk_fma_f32 v[58:59], v[58:59], v[16:17], v[62:63] op_sel:[0,1,0] op_sel_hi:[1,1,0] neg_lo:[0,0,1] neg_hi:[0,0,1]
    v_pk_fma_f32 v[60:61], v[60:61], v[16:17], v[62:63] op_sel:[0,1,0] op_sel_hi:[1,1,0] neg_lo:[0,0,1] neg_hi:[0,0,1]
    v_exp_f32 v54, v54
    v_exp_f32 v55, v55
    v_exp_f32 v56, v56
    v_exp_f32 v57, v57
    v_exp_f32 v58, v58
    v_cvt_pk_bf16_f32 v38, v54, v55
    v_cvt_pk_bf16_f32 v39, v56, v57
    v_exp_f32 v59, v59
    v_mov_b32_dpp v40, v38 row_shl:4 row_mask:0xf bank_mask:0xf
    v_mov_b32_dpp v41, v39 row_shl:4 row_mask:0xf bank_mask:0xf
    v_exp_f32 v60, v60
    v_mov_b32_dpp v42, v38 row_shl:8 row_mask:0xf bank_mask:0xf
    v_mfma_f32_16x16x32_bf16 v[22:25], v[64:67], v[38:41], 0
    v_mov_b32_dpp v43, v39 row_shl:8 row_mask:0xf bank_mask:0xf
    v_mov_b32_dpp v44, v38 row_shl:12 row_mask:0xf bank_mask:0xf
    v_mov_b32_dpp v45, v39 row_shl:12 row_mask:0xf bank_mask:0xf
    v_mfma_f32_16x16x32_bf16 v[26:29], v[68:71], v[38:41], 0
    v_exp_f32 v61, v61
    v_cvt_pk_bf16_f32 v46, v58, v59
    v_mfma_f32_16x16x32_bf16 v[22:25], v[96:99], v[42:45], v[22:25]
    v_cvt_pk_bf16_f32 v47, v60, v61
    v_pk_add_f32 v[54:55], v[54:55], v[56:57]
    v_mov_b32_dpp v48, v46 row_shl:4 row_mask:0xf bank_mask:0xf
    v_mfma_f32_16x16x32_bf16 v[26:29], v[100:103], v[42:45], v[26:29]
    v_mov_b32_dpp v49, v47 row_shl:4 row_mask:0xf bank_mask:0xf
    v_mov_b32_dpp v50, v46 row_shl:8 row_mask:0xf bank_mask:0xf
    v_mov_b32_dpp v51, v47 row_shl:8 row_mask:0xf bank_mask:0xf
    v_mfma_f32_16x16x32_bf16 v[22:25], v[128:131], v[46:49], v[22:25]
    v_mov_b32_dpp v52, v46 row_shl:12 row_mask:0xf bank_mask:0xf
    v_mov_b32_dpp v53, v47 row_shl:12 row_mask:0xf bank_mask:0xf
    v_mfma_f32_16x16x32_bf16 v[26:29], v[132:135], v[46:49], v[26:29]
    v_pk_add_f32 v[58:59], v[58:59], v[60:61]
    v_mfma_f32_16x16x32_bf16 v[22:25], v[160:163], v[50:53], v[22:25]
    v_pk_add_f32 v[54:55], v[54:55], v[58:59]
    v_lshlrev_b32 v61, 6, v1
    v_mfma_f32_16x16x32_bf16 v[26:29], v[164:167], v[50:53], v[26:29]
    v_add_f32 v21, v54, v55
    v_add_u32 v61, s49, v61
    v_mfma_f32_16x16x32_bf16 v[30:33], v[72:75], v[38:41], 0
    s_mov_b64 exec, 15
    ds_write_b32 v61, v62
    s_mov_b64 exec, -1
    v_mfma_f32_16x16x32_bf16 v[30:33], v[104:107], v[42:45], v[30:33]
    v_add_f32_dpp v21, v21, v21 row_ror:4 row_mask:0xf bank_mask:0xf
    v_mfma_f32_16x16x32_bf16 v[30:33], v[136:139], v[46:49], v[30:33]
    v_mov_b32 v62, v61
    v_mfma_f32_16x16x32_bf16 v[30:33], v[168:171], v[50:53], v[30:33]
    v_add_f32_dpp v21, v21, v21 row_ror:8 row_mask:0xf bank_mask:0xf
    v_mfma_f32_16x16x32_bf16 v[34:37], v[76:79], v[38:41], 0
    v_mov_b32 v54, v21
    v_mfma_f32_16x16x32_bf16 v[34:37], v[108:111], v[42:45], v[34:37]
    s_mov_b64 exec, s[98:99]
    ds_write_b128 v13, v[22:25] offset:0
    s_mov_b64 exec, -1
    v_mfma_f32_16x16x32_bf16 v[34:37], v[140:143], v[46:49], v[34:37]
    v_permlane32_swap_b32 v21, v54
    v_mfma_f32_16x16x32_bf16 v[34:37], v[172:175], v[50:53], v[34:37]
    s_mov_b64 exec, s[98:99]
    ds_write_b128 v13, v[26:29] offset:64
    s_mov_b64 exec, -1
    v_add_f32 v21, v21, v54
    v_mfma_f32_16x16x32_bf16 v[54:57], v[80:83], v[38:41], 0
    v_mfma_f32_16x16x32_bf16 v[54:57], v[112:115], v[42:45], v[54:57]
    v_mfma_f32_16x16x32_bf16 v[54:57], v[144:147], v[46:49], v[54:57]
    v_mfma_f32_16x16x32_bf16 v[54:57], v[176:179], v[50:53], v[54:57]
    s_mov_b64 exec, s[98:99]
    ds_write_b128 v13, v[30:33] offset:128
    s_mov_b64 exec, -1
    v_mfma_f32_16x16x32_bf16 v[58:61], v[84:87], v[38:41], 0
    v_mfma_f32_16x16x32_bf16 v[58:61], v[116:119], v[42:45], v[58:61]
    v_mfma_f32_16x16x32_bf16 v[58:61], v[148:151], v[46:49], v[58:61]
    v_mfma_f32_16x16x32_bf16 v[58:61], v[180:183], v[50:53], v[58:61]
    s_mov_b64 exec, s[98:99]
    ds_write_b128 v13, v[34:37] offset:192
    s_mov_b64 exec, -1
    s_waitcnt lgkmcnt(2)
    v_mfma_f32_16x16x32_bf16 v[22:25], v[88:91], v[38:41], 0
    s_mov_b64 exec, s[98:99]
    ds_write_b128 v13, v[54:57] offset:256
    s_mov_b64 exec, -1
    v_mfma_f32_16x16x32_bf16 v[22:25], v[120:123], v[42:45], v[22:25]
    v_mfma_f32_16x16x32_bf16 v[22:25], v[152:155], v[46:49], v[22:25]
    v_mfma_f32_16x16x32_bf16 v[22:25], v[184:187], v[50:53], v[22:25]
    v_mov_b32 v54, v21
    v_mfma_f32_16x16x32_bf16 v[26:29], v[92:95], v[38:41], 0
    v_mfma_f32_16x16x32_bf16 v[26:29], v[124:127], v[42:45], v[26:29]
    v_permlane16_swap_b32 v21, v54
    v_mfma_f32_16x16x32_bf16 v[26:29], v[156:159], v[46:49], v[26:29]
    v_add_f32 v21, v21, v54
    v_mfma_f32_16x16x32_bf16 v[26:29], v[188:191], v[50:53], v[26:29]
    s_mov_b64 exec, s[98:99]
    ds_write_b128 v13, v[58:61] offset:320
    s_mov_b64 exec, -1
    s_mov_b64 exec, 15
    ds_write_b32 v62, v21 offset:32
    s_mov_b64 exec, s[98:99]
    ds_write_b128 v13, v[22:25] offset:384
    s_add_u32 s95, s27, 4
    s_min_u32 s95, s95, 7
    s_nop 0
    s_lshl_b32 s48, s3, 6
    s_add_u32 s48, s48, 147968
    ds_write_b128 v13, v[26:29] offset:448
    s_mov_b64 exec, -1
    v_mov_b32 v54, s48
    v_add_u32 v55, 0, v14
L_a2D:
    s_cmp_lt_u32 s24, 256
    s_cbranch_scc1 L_a2S
L_a2Sb:
    s_waitcnt lgkmcnt(0)
    s_barrier
    ds_read_b128 v[38:41], v54
    ds_read_b128 v[46:49], v54 offset:32
    ds_read_b128 v[22:25], v55
    ds_read_b128 v[26:29], v55 offset:2112
    v_mov_b32 v57, s89
    s_waitcnt lgkmcnt(3)
    v_max3_f32 v42, v38, v39, v40
    v_max_f32 v42, v42, v41
    v_pk_add_f32 v[38:39], v[38:39], v[42:43] op_sel_hi:[1,0] neg_lo:[0,1] neg_hi:[0,1]
    v_pk_add_f32 v[40:41], v[40:41], v[42:43] op_sel_hi:[1,0] neg_lo:[0,1] neg_hi:[0,1]
    v_exp_f32 v38, v38
    v_exp_f32 v39, v39
    v_exp_f32 v40, v40
    v_exp_f32 v41, v41
    s_waitcnt lgkmcnt(0)
    v_pk_mul_f32 v[46:47], v[46:47], v[38:39]
    v_pk_fma_f32 v[46:47], v[48:49], v[40:41], v[46:47]
    s_mov_b32 exec_lo, 0
    v_pk_mov_b32 v[38:39], v[40:41], v[40:41] op_sel:[0,1]
    s_mov_b32 exec_lo, -1
    v_pk_mul_f32 v[22:23], v[22:23], v[38:39] op_sel_hi:[1,0]
    v_pk_mul_f32 v[24:25], v[24:25], v[38:39] op_sel_hi:[1,0]
    v_pk_fma_f32 v[22:23], v[26:27], v[38:39], v[22:23] op_sel:[0,1,0] op_sel_hi:[1,1,1]
    v_pk_fma_f32 v[24:25], v[28:29], v[38:39], v[24:25] op_sel:[0,1,0] op_sel_hi:[1,1,1]
    v_add_f32 v43, v46, v47
L_cjoin:
    v_and_or_b32 v42, v42, -2, s42
    v_permlane32_swap_b32 v22, v24
    v_permlane32_swap_b32 v23, v25
    s_nop 0
    v_pk_add_f32 v[22:23], v[22:23], v[24:25]
    v_and_or_b32 v22, v22, -2, s42
    s_cmp_eq_u32 s30, 0
    s_cbranch_scc1 Lsm_91
    global_store_dwordx2 v3, v[22:23], s[32:33]
    s_mov_b64 exec, 1
    global_store_dwordx2 v57, v[42:43], s[32:33]
Lsb_92:
    s_mov_b64 exec, -1
    s_and_b32 s48, s28, 3
    s_cmp_eq_u32 s48, 3
    s_cbranch_scc1 L_p37
L_p7w:
    s_cmp_eq_u32 s28, 0
    s_cbranch_scc1 L_p0a
L_p0a_back:
    s_cmp_lt_u32 s24, 256
    s_cbranch_scc1 Lsv_109
Lsw_110:
L_wo:
    s_mul_i32 s48, s3, 272
    s_add_u32 s48, s48, 150912
    v_add_u32 v62, s48, v4
    s_mov_b32 s82, 16
    s_cmp_lt_u32 s24, s13
    s_cbranch_scc1 Ldl_111
    s_cmp_le_u32 s34, s95
    s_cbranch_scc1 Lds_114
    s_sleep 3
Ldb_112:
L_gA:
    s_add_u32 s31, s31, 1
    s_cmp_gt_u32 s31, 1000000
    s_cbranch_scc1 L_done
    global_load_dwordx2 v[54:55], v5, s[32:33] sc1
    global_load_dwordx4 v[22:25], v2, s[32:33] offset:0 sc1
    global_load_dwordx4 v[26:29], v2, s[32:33] offset:1024 sc1
    global_load_dwordx4 v[30:33], v2, s[32:33] offset:2048 sc1
    global_load_dwordx4 v[34:37], v2, s[32:33] offset:3072 sc1
    s_mov_b64 exec, -1
    s_cmp_lt_u32 s24, s13
    s_cbranch_scc1 Lgs_119
    s_mov_b32 s100, s24
    s_waitcnt vmcnt(0)
Lgd_118:
    v_max_f32_dpp v56, v54, v54 quad_perm:[1,0,3,2] row_mask:0xf bank_mask:0xf
    s_cmp_lg_u32 s42, 0
    s_cbranch_scc1 Ltg_123
    v_bitop3_b32 v57, v22, v24, v26 bitop3:0xfe
    v_bitop3_b32 v57, v57, v28, v30 bitop3:0xfe
    v_max_f32_dpp v56, v56, v56 quad_perm:[2,3,0,1] row_mask:0xf bank_mask:0xf
    v_bitop3_b32 v57, v57, v32, v34 bitop3:0xfe
    v_bitop3_b32 v57, v57, v36, v54 bitop3:0xfe
Ltb_124:
    v_max_f32_dpp v56, v56, v56 row_half_mirror row_mask:0xf bank_mask:0xf
    v_and_b32 v57, 1, v57
    v_cmp_ne_u32 vcc, s42, v57
    v_sub_f32 v56, v54, v56
    s_cbranch_vccnz Ltr_125
    v_exp_f32 v54, v56
    s_nop 1
    v_mul_f32_dpp v58, v54, v22 row_newbcast:0 row_mask:0xf bank_mask:0xf
    v_mul_f32 v55, v55, v54
    v_mul_f32_dpp v59, v54, v23 row_newbcast:0 row_mask:0xf bank_mask:0xf
    v_mul_f32_dpp v60, v54, v24 row_newbcast:0 row_mask:0xf bank_mask:0xf
    v_add_f32_dpp v55, v55, v55 quad_perm:[1,0,3,2] row_mask:0xf bank_mask:0xf
    v_mul_f32_dpp v61, v54, v25 row_newbcast:0 row_mask:0xf bank_mask:0xf
    v_fmac_f32_dpp v58, v54, v26 row_newbcast:2 row_mask:0xf bank_mask:0xf
    v_add_f32_dpp v55, v55, v55 quad_perm:[2,3,0,1] row_mask:0xf bank_mask:0xf
    v_fmac_f32_dpp v59, v54, v27 row_newbcast:2 row_mask:0xf bank_mask:0xf
    v_fmac_f32_dpp v60, v54, v28 row_newbcast:2 row_mask:0xf bank_mask:0xf
    v_add_f32_dpp v55, v55, v55 row_half_mirror row_mask:0xf bank_mask:0xf
    v_fmac_f32_dpp v61, v54, v29 row_newbcast:2 row_mask:0xf bank_mask:0xf
    v_rcp_f32 v55, v55
    v_fmac_f32_dpp v58, v54, v30 row_newbcast:4 row_mask:0xf bank_mask:0xf
    v_fmac_f32_dpp v60, v54, v32 row_newbcast:4 row_mask:0xf bank_mask:0xf
    v_fmac_f32_dpp v59, v54, v31 row_newbcast:4 row_mask:0xf bank_mask:0xf
    v_fmac_f32_dpp v61, v54, v33 row_newbcast:4 row_mask:0xf bank_mask:0xf
    v_fmac_f32_dpp v58, v54, v34 row_newbcast:6 row_mask:0xf bank_mask:0xf
    v_fmac_f32_dpp v60, v54, v36 row_newbcast:6 row_mask:0xf bank_mask:0xf
    v_fmac_f32_dpp v59, v54, v35 row_newbcast:6 row_mask:0xf bank_mask:0xf
    v_fmac_f32_dpp v61, v54, v37 row_newbcast:6 row_mask:0xf bank_mask:0xf
    v_permlane32_swap_b32 v58, v60
    s_nop 0
    v_permlane32_swap_b32 v59, v61
    s_nop 0
    v_pk_add_f32 v[58:59], v[58:59], v[60:61]
    v_pk_mul_f32 v[58:59], v[58:59], v[54:55] op_sel:[0,1] op_sel_hi:[1,1]
    v_cvt_pk_bf16_f32 v22, v58, v59
    ds_write_b32 v62, v22
    s_waitcnt lgkmcnt(0)
    s_barrier
    ds_read_b128 v[30:33], v12 offset:2688
    ds_read_b128 v[34:37], v12 offset:2752
    ds_read_b128 v[38:41], v12 offset:2816
    ds_read_b128 v[42:45], v12 offset:2880
    s_bitcmp1_b32 s39, 0
    s_cbranch_scc1 L_woB
    s_waitcnt lgkmcnt(3)
    v_mfma_f32_16x16x32_bf16 v[22:25], a[192:195], v[30:33], 0
    s_waitcnt lgkmcnt(2)
    v_mfma_f32_16x16x32_bf16 v[22:25], a[196:199], v[34:37], v[22:25]
    s_waitcnt lgkmcnt(1)
    v_mfma_f32_16x16x32_bf16 v[22:25], a[200:203], v[38:41], v[22:25]
    s_waitcnt lgkmcnt(0)
    v_mfma_f32_16x16x32_bf16 v[22:25], a[204:207], v[42:45], v[22:25]
    s_nop 0
L_woD:
    s_mov_b64 exec, s[98:99]
    s_nop 5
    v_and_or_b32 v22, v22, -2, s78
    global_store_dwordx4 v6, v[22:25], s[76:77] sc1
    s_mov_b64 exec, -1
    s_cmp_lg_u32 s88, 0
    s_cbranch_scc1 L_stret
    s_cmp_eq_u32 s28, 7
    s_cbranch_scc1 L_p7
    s_cmp_lt_u32 s24, 256
    s_cbranch_scc1 Lsv_126
Lsw_127:
    s_and_b32 s48, s28, 3
    s_cbranch_scc0 L_x0
L_nox0:
    s_mov_b32 s36, s95
    s_lshl_b32 s48, s53, 15
    s_lshl_b32 s49, s3, 13
    s_add_u32 s48, s48, s49
    s_add_u32 s48, s48, 1052672
    s_add_u32 s44, s76, s48
    s_addc_u32 s45, s77, 0
    v_lshlrev_b32 v57, 4, v1
    s_mul_i32 s48, s3, 144
    s_add_u32 s48, s48, 152000
    v_and_b32 v58, 0x30, v1
    v_add_u32 v59, 153152, v58
    v_add_u32 v58, s48, v58
    s_mov_b32 vcc_lo, 0xff00ff00
    s_mov_b32 vcc_hi, 0xff00ff00
    v_cndmask_b32 v58, v58, v59, vcc
    v_lshrrev_b32 v59, 5, v1
    v_lshlrev_b32 v59, 2, v59
    v_sub_u32 v59, s38, v59
    s_lshl_b32 s96, 1, s3
    s_mov_b32 s97, s96
    s_mov_b32 s82, 16
    s_cmp_lt_u32 s24, s13
    s_cbranch_scc1 Ldl_128
    s_cmp_le_u32 s35, s36
    s_cbranch_scc1 Lds_131
    s_cmp_eq_u32 s94, 0
    s_cbranch_scc1 Ldb_129
    s_sleep 6
Ldb_129:
L_gB:
    s_add_u32 s31, s31, 1
    s_cmp_gt_u32 s31, 1000000
    s_cbranch_scc1 L_done
    global_load_dwordx4 v[22:25], v57, s[44:45] offset:-4096 sc1
    global_load_dwordx4 v[26:29], v57, s[44:45] offset:-3072 sc1
    global_load_dwordx4 v[30:33], v57, s[44:45] offset:-2048 sc1
    global_load_dwordx4 v[34:37], v57, s[44:45] offset:-1024 sc1
    global_load_dwordx4 v[38:41], v57, s[44:45] offset:0 sc1
    global_load_dwordx4 v[42:45], v57, s[44:45] offset:1024 sc1
    global_load_dwordx4 v[46:49], v57, s[44:45] offset:2048 sc1
    global_load_dwordx4 v[50:53], v57, s[44:45] offset:3072 sc1
    s_mov_b64 exec, -1
    s_cmp_lt_u32 s24, s13
    s_cbranch_scc1 Lgs_136
    s_mov_b32 s100, s24
    s_waitcnt vmcnt(0)
Lgd_135:
    s_cmp_lg_u32 s78, 0
    s_cbranch_scc1 Ltg_140
    v_bitop3_b32 v56, v22, v26, v30 bitop3:0xfe
    v_bitop3_b32 v56, v56, v34, v38 bitop3:0xfe
    v_bitop3_b32 v56, v56, v42, v46 bitop3:0xfe
    v_bitop3_b32 v56, v56, v50, v50 bitop3:0xfe
Ltb_141:
    v_and_b32 v56, 1, v56
    v_cmp_ne_u32 vcc, s78, v56
    s_cbranch_vccnz Ltr_142
    v_pk_add_f32 v[22:23], v[22:23], v[38:39]
    v_pk_add_f32 v[24:25], v[24:25], v[40:41]
    v_pk_add_f32 v[26:27], v[26:27], v[42:43]
    v_pk_add_f32 v[28:29], v[28:29], v[44:45]
    v_pk_add_f32 v[30:31], v[30:31], v[46:47]
    v_pk_add_f32 v[32:33], v[32:33], v[48:49]
    v_pk_add_f32 v[34:35], v[34:35], v[50:51]
    v_pk_add_f32 v[36:37], v[36:37], v[52:53]
    v_pk_add_f32 v[22:23], v[22:23], v[30:31]
    v_pk_add_f32 v[24:25], v[24:25], v[32:33]
    v_pk_add_f32 v[26:27], v[26:27], v[34:35]
    v_pk_add_f32 v[28:29], v[28:29], v[36:37]
    v_pk_add_f32 v[22:23], v[22:23], v[26:27]
    v_pk_add_f32 v[24:25], v[24:25], v[28:29]
    s_nop 1
    v_permlane32_swap_b32 v22, v24
    v_permlane32_swap_b32 v23, v25
    s_nop 0
    v_pk_add_f32 v[22:23], v[22:23], v[24:25]
    s_nop 1
    v_permlane16_swap_b32 v22, v23
    s_nop 0
    v_add_f32 v22, v22, v23
    v_cvt_pk_bf16_f32 v22, 0, v22
    s_cmp_lg_u32 s88, 0
    s_cbranch_scc1 L_stret
    v_add_f32 v16, v16, v22
    v_cvt_pk_bf16_f32 v16, 0, v16
    ds_write_b16_d16_hi v15, v16
    s_bitcmp0_b32 s28, 1
    s_cselect_b32 s54, 8, s54
    s_cselect_b32 s55, 8, s55
    s_cselect_b32 s56, 5, s56
    s_cselect_b32 s90, 999, s90
    s_cmp_eq_u32 s28, 1
    s_cselect_b32 s90, 192, s90
    s_waitcnt lgkmcnt(0)
    s_barrier
    ds_read_b128 v[30:33], v20
    ds_read_b128 v[34:37], v20 offset:64
    ds_read_b128 v[38:41], v58
    ds_read_b128 v[42:45], v58 offset:64
    s_bitcmp1_b32 s28, 0
    s_cbranch_scc0 L_wqB
    s_waitcnt lgkmcnt(3)
    v_mfma_f32_16x16x32_bf16 v[22:25], a[208:211], v[30:33], 0
    v_mfma_f32_16x16x32_bf16 v[26:29], a[216:219], v[30:33], 0
    s_waitcnt lgkmcnt(2)
    v_mfma_f32_16x16x32_bf16 v[22:25], a[212:215], v[34:37], v[22:25]
    v_mfma_f32_16x16x32_bf16 v[26:29], a[220:223], v[34:37], v[26:29]
L_wqD:
    s_waitcnt lgkmcnt(0)
    v_mfma_f32_16x16x32_bf16 v[46:49], v[38:41], v[30:33], 0
    v_mfma_f32_16x16x32_bf16 v[46:49], v[42:45], v[34:37], v[46:49]
    s_mov_b64 exec, s[98:99]
    s_nop 2
    v_and_or_b32 v22, v22, -2, s42
    v_and_or_b32 v26, v26, -2, s42
    s_cmp_eq_u32 s30, 0
    s_cbranch_scc1 Lsm_143
    global_store_dwordx4 v7, v[22:25], s[32:33]
    global_store_dwordx4 v7, v[26:29], s[32:33] offset:64
    s_mov_b64 exec, s[96:97]
    v_and_or_b32 v46, v46, -2, s42
    global_store_dword v59, v46, s[32:33] offset:4
Lsb_144:
    s_mov_b64 exec, -1
    s_bitcmp0_b32 s28, 0
    s_cbranch_scc1 L_p24
L_next:
    s_cmp_lt_u32 s24, 256
    s_cbranch_scc1 Lsv_145
Lsw_146:
    s_add_u32 s28, s28, 1
    s_and_b32 s48, s28, 1
    s_lshl_b32 s48, s48, 21
    s_add_u32 s48, s48, 1048576
    s_add_u32 s32, s6, s48
    s_addc_u32 s33, s7, 0
    s_branch L_phase
L_p24:
    s_cmp_eq_u32 s28, 4
    s_cbranch_scc1 L_dwo
    s_cmp_lg_u32 s28, 2
    s_cbranch_scc1 L_next
    s_lshl_b32 s48, s3, 8
    s_add_u32 s48, s48, 159424
    v_lshl_add_u32 v30, v1, 2, s48
    ds_write_b32 v30, v16
    s_branch L_next
L_p37:
    s_cmp_eq_u32 s28, 7
    s_cbranch_scc1 L_p7w
    s_add_u32 s44, s32, 2097152
    s_addc_u32 s45, s33, 0
    v_mov_b32 v30, s42
    v_mov_b32 v31, s42
    v_mov_b32 v34, s38
    s_cmp_eq_u32 s30, 0
    s_cbranch_scc1 Lsm_147
    global_store_dwordx2 v3, v[22:23], s[44:45]
    s_mov_b64 exec, s[98:99]
    global_store_dwordx4 v7, v[30:33], s[32:33]
    global_store_dwordx4 v7, v[30:33], s[32:33] offset:64
    s_mov_b64 exec, 1
    global_store_dwordx2 v57, v[42:43], s[44:45]
    global_store_dwordx2 v34, v[30:31], s[32:33]
Lsb_148:
    s_mov_b64 exec, -1
    s_barrier
    s_branch L_next
L_dwo:
    s_add_u32 s32, s6, 5242880
    s_addc_u32 s33, s7, 0
    s_mov_b64 s[76:77], s[32:33]
    s_mov_b32 s42, 1
    s_mov_b32 s78, 1
    s_mov_b32 s39, 1
    s_mov_b32 s88, 1
    s_call_b64 s[92:93], L_wo2
    s_branch L_next
L_p7:
    s_and_b32 s48, s4, 3
    s_xor_b32 s48, s48, s3
    s_or_b32 s48, s48, s52
    s_cmp_lg_u32 s48, 0
    s_cbranch_scc1 L_done
    s_lshl_b32 s48, s53, 15
    s_lshl_b32 s49, s3, 13
    s_add_u32 s48, s48, s49
    s_add_u32 s48, s48, 1052672
    s_cmp_ge_u32 s4, 4
    s_cselect_b32 s49, 4194304, 0
    s_cselect_b32 s50, 0, 4096
    s_add_u32 s48, s48, s49
    s_add_u32 s44, s76, s48
    s_addc_u32 s45, s77, 0
    v_lshlrev_b32 v57, 4, v1
    s_mul_i32 s48, s3, 880
    s_lshl_b32 s49, s53, 7
    s_add_u32 s48, s48, s49
    s_add_u32 s48, s48, s50
    s_sub_u32 s48, s48, 152000
    v_add_u32 v58, s48, v15
    s_cmp_lt_u32 s4, 4
    s_cbranch_scc1 L_p7a
    s_lshl_b32 s48, s3, 8
    s_add_u32 s48, s48, 159424
    v_lshl_add_u32 v59, v1, 2, s48
    ds_read_b32 v16, v59
    s_waitcnt lgkmcnt(0)
    s_branch L_p7b
L_p7a:
    s_sleep 2
L_p7b:
    s_mov_b32 s88, 1
    s_call_b64 s[92:93], L_gB
    v_add_f32 v16, v16, v22
    v_cvt_pk_bf16_f32 v16, 0, v16
    global_store_short_d16_hi v58, v16, s[8:9]
L_done:
    s_mov_b64 exec, -1
    s_endpgm
L_stret:
    s_mov_b32 s88, 0
    s_setpc_b64 s[92:93]
L_seg:
    s_add_u32 s0, s16, 524288
    s_addc_u32 s1, s17, 0
    s_mov_b64 s[16:17], s[18:19]
    s_mov_b64 s[18:19], s[0:1]
    s_sub_u32 s26, s26, 16384
    s_xor_b32 s26, s26, 65536
    s_cmp_ge_u32 s24, s90
    s_cselect_b32 s54, 5, s54
    s_cselect_b32 s55, 5, s55
    s_cselect_b32 s56, 4, s56
    s_and_b32 s0, s24, 63
    s_cbranch_scc1 L_seg_ret
    s_add_u32 s0, s16, 32505856
    s_addc_u32 s1, s17, 0
    s_mov_b64 s[16:17], s[20:21]
    s_mov_b64 s[20:21], s[0:1]
    s_add_u32 s0, s18, 32505856
    s_addc_u32 s1, s19, 0
    s_mov_b64 s[18:19], s[22:23]
    s_mov_b64 s[22:23], s[0:1]
L_seg_ret:
    s_setpc_b64 s[58:59]
L_service:
    s_getreg_b32 s0, hwreg(HW_REG_IB_STS)
    s_and_b32 s1, s0, 15
    s_bfe_u32 s0, s0, 131094
    s_lshl_b32 s0, s0, 4
    s_add_u32 s0, s0, s1
    s_min_u32 s0, s0, s24
    s_sub_u32 s29, s24, s0
    s_max_u32 s29, s29, s100
    s_lshl_b32 s48, s34, 5
    s_add_u32 s48, s48, 16
    s_cmp_ge_u32 s29, s48
    s_cbranch_scc1 L_svK
L_svV:
    s_lshl_b32 s48, s35, 5
    s_add_u32 s48, s48, 32
    s_cmp_ge_u32 s29, s48
    s_cbranch_scc1 L_svV2
L_svR:
    s_waitcnt lgkmcnt(0)
    s_setpc_b64 s[62:63]
L_svK:
    s_cmp_gt_u32 s34, s95
    s_cbranch_scc1 L_svV
    s_mul_i32 s48, s34, 86
    s_lshr_b32 s48, s48, 8
    s_mul_i32 s48, s48, 3
    s_sub_u32 s48, s34, s48
    s_cmp_eq_u32 s48, 1
    s_cbranch_scc1 L_kc1
    s_cmp_eq_u32 s48, 2
    s_cbranch_scc1 L_kc2
    ds_read_b128 a[0:3], v10 offset:0
    ds_read_b128 a[16:19], v10 offset:4096
    ds_read_b128 a[32:35], v10 offset:8192
    ds_read_b128 a[48:51], v10 offset:12288
    v_xor_b32 v21, 64, v10
    ds_read_b128 a[4:7], v21 offset:0
    ds_read_b128 a[20:23], v21 offset:4096
    ds_read_b128 a[36:39], v21 offset:8192
    ds_read_b128 a[52:55], v21 offset:12288
    v_xor_b32 v21, 128, v10
    ds_read_b128 a[8:11], v21 offset:0
    ds_read_b128 a[24:27], v21 offset:4096
    ds_read_b128 a[40:43], v21 offset:8192
    ds_read_b128 a[56:59], v21 offset:12288
    v_xor_b32 v21, 192, v10
    ds_read_b128 a[12:15], v21 offset:0
    ds_read_b128 a[28:31], v21 offset:4096
    ds_read_b128 a[44:47], v21 offset:8192
    ds_read_b128 a[60:63], v21 offset:12288
    s_branch L_kcD
L_kc1:
    ds_read_b128 a[64:67], v10 offset:0
    ds_read_b128 a[80:83], v10 offset:4096
    ds_read_b128 a[96:99], v10 offset:8192
    ds_read_b128 a[112:115], v10 offset:12288
    v_xor_b32 v21, 64, v10
    ds_read_b128 a[68:71], v21 offset:0
    ds_read_b128 a[84:87], v21 offset:4096
    ds_read_b128 a[100:103], v21 offset:8192
    ds_read_b128 a[116:119], v21 offset:12288
    v_xor_b32 v21, 128, v10
    ds_read_b128 a[72:75], v21 offset:0
    ds_read_b128 a[88:91], v21 offset:4096
    ds_read_b128 a[104:107], v21 offset:8192
    ds_read_b128 a[120:123], v21 offset:12288
    v_xor_b32 v21, 192, v10
    ds_read_b128 a[76:79], v21 offset:0
    ds_read_b128 a[92:95], v21 offset:4096
    ds_read_b128 a[108:111], v21 offset:8192
    ds_read_b128 a[124:127], v21 offset:12288
    s_branch L_kcD
L_kc2:
    ds_read_b128 a[128:131], v10 offset:0
    ds_read_b128 a[144:147], v10 offset:4096
    ds_read_b128 a[160:163], v10 offset:8192
    ds_read_b128 a[176:179], v10 offset:12288
    v_xor_b32 v21, 64, v10
    ds_read_b128 a[132:135], v21 offset:0
    ds_read_b128 a[148:151], v21 offset:4096
    ds_read_b128 a[164:167], v21 offset:8192
    ds_read_b128 a[180:183], v21 offset:12288
    v_xor_b32 v21, 128, v10
    ds_read_b128 a[136:139], v21 offset:0
    ds_read_b128 a[152:155], v21 offset:4096
    ds_read_b128 a[168:171], v21 offset:8192
    ds_read_b128 a[184:187], v21 offset:12288
    v_xor_b32 v21, 192, v10
    ds_read_b128 a[140:143], v21 offset:0
    ds_read_b128 a[156:159], v21 offset:4096
    ds_read_b128 a[172:175], v21 offset:8192
    ds_read_b128 a[188:191], v21 offset:12288
L_kcD:
    s_add_u32 s34, s34, 1
    s_waitcnt lgkmcnt(0)
    s_lshl_b32 s48, s34, 5
    s_add_u32 s48, s48, 32
    s_lshl_b32 s49, s35, 5
    s_add_u32 s49, s49, 48
    s_min_u32 s25, s48, s49
    s_min_u32 s25, s25, s13
    s_cmp_ge_u32 s24, s25
    s_cbranch_scc1 Lpk_149
    s_getreg_b32 s0, hwreg(HW_REG_IB_STS)
    s_and_b32 s0, s0, 0xc0000f
    s_cmp_gt_u32 s0, s55
    s_cbranch_scc1 Lpk_149
    s_mov_b32 m0, s26
    s_add_u32 s0, s16, s101
    s_addc_u32 s1, s17, 0
    s_add_u32 s24, s24, 2
    global_load_lds_dwordx4 v8, s[0:1] nt
    global_load_lds_dwordx4 v9, s[0:1] offset:1024 nt
    s_add_u32 s101, s101, 65536
    s_and_b32 s101, s101, 0x7ffff
    s_add_u32 s26, s26, 2048
    s_and_b32 s0, s24, 15
    s_cbranch_scc0 Lps_150
Lpk_149:
    s_cmp_ge_u32 s24, s25
    s_cbranch_scc1 Lpk_151
    s_getreg_b32 s0, hwreg(HW_REG_IB_STS)
    s_and_b32 s0, s0, 0xc0000f
    s_cmp_gt_u32 s0, s55
    s_cbranch_scc1 Lpk_151
    s_mov_b32 m0, s26
    s_add_u32 s0, s16, s101
    s_addc_u32 s1, s17, 0
    s_add_u32 s24, s24, 2
    global_load_lds_dwordx4 v8, s[0:1] nt
    global_load_lds_dwordx4 v9, s[0:1] offset:1024 nt
    s_add_u32 s101, s101, 65536
    s_and_b32 s101, s101, 0x7ffff
    s_add_u32 s26, s26, 2048
    s_and_b32 s0, s24, 15
    s_cbranch_scc0 Lps_152
Lpk_151:
    s_branch L_svV
L_svV2:
    s_cmp_gt_u32 s35, s36
    s_cbranch_scc1 L_svR
    s_mul_i32 s48, s35, 86
    s_lshr_b32 s48, s48, 8
    s_mul_i32 s48, s48, 3
    s_sub_u32 s48, s35, s48
    s_cmp_eq_u32 s48, 1
    s_cbranch_scc1 L_vc1
    s_cmp_eq_u32 s48, 2
    s_cbranch_scc1 L_vc2
    ds_read_b64_tr_b16 v[64:65], v11 offset:0
    ds_read_b64_tr_b16 v[66:67], v11 offset:4096
    ds_read_b64_tr_b16 v[96:97], v11 offset:8192
    ds_read_b64_tr_b16 v[98:99], v11 offset:12288
    v_xor_b32 v21, 32, v11
    ds_read_b64_tr_b16 v[68:69], v21 offset:0
    ds_read_b64_tr_b16 v[70:71], v21 offset:4096
    ds_read_b64_tr_b16 v[100:101], v21 offset:8192
    ds_read_b64_tr_b16 v[102:103], v21 offset:12288
    v_xor_b32 v21, 64, v11
    ds_read_b64_tr_b16 v[72:73], v21 offset:0
    ds_read_b64_tr_b16 v[74:75], v21 offset:4096
    ds_read_b64_tr_b16 v[104:105], v21 offset:8192
    ds_read_b64_tr_b16 v[106:107], v21 offset:12288
    v_xor_b32 v21, 96, v11
    ds_read_b64_tr_b16 v[76:77], v21 offset:0
    ds_read_b64_tr_b16 v[78:79], v21 offset:4096
    ds_read_b64_tr_b16 v[108:109], v21 offset:8192
    ds_read_b64_tr_b16 v[110:111], v21 offset:12288
    v_xor_b32 v21, 128, v11
    ds_read_b64_tr_b16 v[80:81], v21 offset:0
    ds_read_b64_tr_b16 v[82:83], v21 offset:4096
    ds_read_b64_tr_b16 v[112:113], v21 offset:8192
    ds_read_b64_tr_b16 v[114:115], v21 offset:12288
    v_xor_b32 v21, 160, v11
    ds_read_b64_tr_b16 v[84:85], v21 offset:0
    ds_read_b64_tr_b16 v[86:87], v21 offset:4096
    ds_read_b64_tr_b16 v[116:117], v21 offset:8192
    ds_read_b64_tr_b16 v[118:119], v21 offset:12288
    v_xor_b32 v21, 192, v11
    ds_read_b64_tr_b16 v[88:89], v21 offset:0
    ds_read_b64_tr_b16 v[90:91], v21 offset:4096
    ds_read_b64_tr_b16 v[120:121], v21 offset:8192
    ds_read_b64_tr_b16 v[122:123], v21 offset:12288
    v_xor_b32 v21, 224, v11
    ds_read_b64_tr_b16 v[92:93], v21 offset:0
    ds_read_b64_tr_b16 v[94:95], v21 offset:4096
    ds_read_b64_tr_b16 v[124:125], v21 offset:8192
    ds_read_b64_tr_b16 v[126:127], v21 offset:12288
    s_branch L_vcD
L_vc1:
    ds_read_b64_tr_b16 v[128:129], v11 offset:0
    ds_read_b64_tr_b16 v[130:131], v11 offset:4096
    ds_read_b64_tr_b16 v[160:161], v11 offset:8192
    ds_read_b64_tr_b16 v[162:163], v11 offset:12288
    v_xor_b32 v21, 32, v11
    ds_read_b64_tr_b16 v[132:133], v21 offset:0
    ds_read_b64_tr_b16 v[134:135], v21 offset:4096
    ds_read_b64_tr_b16 v[164:165], v21 offset:8192
    ds_read_b64_tr_b16 v[166:167], v21 offset:12288
    v_xor_b32 v21, 64, v11
    ds_read_b64_tr_b16 v[136:137], v21 offset:0
    ds_read_b64_tr_b16 v[138:139], v21 offset:4096
    ds_read_b64_tr_b16 v[168:169], v21 offset:8192
    ds_read_b64_tr_b16 v[170:171], v21 offset:12288
    v_xor_b32 v21, 96, v11
    ds_read_b64_tr_b16 v[140:141], v21 offset:0
    ds_read_b64_tr_b16 v[142:143], v21 offset:4096
    ds_read_b64_tr_b16 v[172:173], v21 offset:8192
    ds_read_b64_tr_b16 v[174:175], v21 offset:12288
    v_xor_b32 v21, 128, v11
    ds_read_b64_tr_b16 v[144:145], v21 offset:0
    ds_read_b64_tr_b16 v[146:147], v21 offset:4096
    ds_read_b64_tr_b16 v[176:177], v21 offset:8192
    ds_read_b64_tr_b16 v[178:179], v21 offset:12288
    v_xor_b32 v21, 160, v11
    ds_read_b64_tr_b16 v[148:149], v21 offset:0
    ds_read_b64_tr_b16 v[150:151], v21 offset:4096
    ds_read_b64_tr_b16 v[180:181], v21 offset:8192
    ds_read_b64_tr_b16 v[182:183], v21 offset:12288
    v_xor_b32 v21, 192, v11
    ds_read_b64_tr_b16 v[152:153], v21 offset:0
    ds_read_b64_tr_b16 v[154:155], v21 offset:4096
    ds_read_b64_tr_b16 v[184:185], v21 offset:8192
    ds_read_b64_tr_b16 v[186:187], v21 offset:12288
    v_xor_b32 v21, 224, v11
    ds_read_b64_tr_b16 v[156:157], v21 offset:0
    ds_read_b64_tr_b16 v[158:159], v21 offset:4096
    ds_read_b64_tr_b16 v[188:189], v21 offset:8192
    ds_read_b64_tr_b16 v[190:191], v21 offset:12288
    s_branch L_vcD
L_vc2:
    ds_read_b64_tr_b16 v[192:193], v11 offset:0
    ds_read_b64_tr_b16 v[194:195], v11 offset:4096
    ds_read_b64_tr_b16 v[224:225], v11 offset:8192
    ds_read_b64_tr_b16 v[226:227], v11 offset:12288
    v_xor_b32 v21, 32, v11
    ds_read_b64_tr_b16 v[196:197], v21 offset:0
    ds_read_b64_tr_b16 v[198:199], v21 offset:4096
    ds_read_b64_tr_b16 v[228:229], v21 offset:8192
    ds_read_b64_tr_b16 v[230:231], v21 offset:12288
    v_xor_b32 v21, 64, v11
    ds_read_b64_tr_b16 v[200:201], v21 offset:0
    ds_read_b64_tr_b16 v[202:203], v21 offset:4096
    ds_read_b64_tr_b16 v[232:233], v21 offset:8192
    ds_read_b64_tr_b16 v[234:235], v21 offset:12288
    v_xor_b32 v21, 96, v11
    ds_read_b64_tr_b16 v[204:205], v21 offset:0
    ds_read_b64_tr_b16 v[206:207], v21 offset:4096
    ds_read_b64_tr_b16 v[236:237], v21 offset:8192
    ds_read_b64_tr_b16 v[238:239], v21 offset:12288
    v_xor_b32 v21, 128, v11
    ds_read_b64_tr_b16 v[208:209], v21 offset:0
    ds_read_b64_tr_b16 v[210:211], v21 offset:4096
    ds_read_b64_tr_b16 v[240:241], v21 offset:8192
    ds_read_b64_tr_b16 v[242:243], v21 offset:12288
    v_xor_b32 v21, 160, v11
    ds_read_b64_tr_b16 v[212:213], v21 offset:0
    ds_read_b64_tr_b16 v[214:215], v21 offset:4096
    ds_read_b64_tr_b16 v[244:245], v21 offset:8192
    ds_read_b64_tr_b16 v[246:247], v21 offset:12288
    v_xor_b32 v21, 192, v11
    ds_read_b64_tr_b16 v[216:217], v21 offset:0
    ds_read_b64_tr_b16 v[218:219], v21 offset:4096
    ds_read_b64_tr_b16 v[248:249], v21 offset:8192
    ds_read_b64_tr_b16 v[250:251], v21 offset:12288
    v_xor_b32 v21, 224, v11
    ds_read_b64_tr_b16 v[220:221], v21 offset:0
    ds_read_b64_tr_b16 v[222:223], v21 offset:4096
    ds_read_b64_tr_b16 v[252:253], v21 offset:8192
    ds_read_b64_tr_b16 v[254:255], v21 offset:12288
L_vcD:
    s_add_u32 s35, s35, 1
    s_waitcnt lgkmcnt(0)
    s_lshl_b32 s48, s34, 5
    s_add_u32 s48, s48, 32
    s_lshl_b32 s49, s35, 5
    s_add_u32 s49, s49, 48
    s_min_u32 s25, s48, s49
    s_min_u32 s25, s25, s13
    s_setpc_b64 s[62:63]
L_att:
    s_cmp_gt_u32 s35, s27
    s_cbranch_scc1 L_attreg
    s_call_b64 s[62:63], L_service
    s_cmp_gt_u32 s35, s27
    s_cbranch_scc1 L_attreg
    s_cmp_le_u32 s27, s36
    s_cbranch_scc1 L_attw
    s_lshl_b32 s48, s27, 5
    s_add_u32 s48, s48, 16
    s_cmp_ge_u32 s29, s48
    s_cbranch_scc1 L_attlds
L_attw:
    s_add_u32 s31, s31, 1
    s_cmp_gt_u32 s31, 1000000
    s_cbranch_scc1 L_done
    s_cmp_ge_u32 s24, s25
    s_cbranch_scc1 Lpk_153
    s_getreg_b32 s0, hwreg(HW_REG_IB_STS)
    s_and_b32 s0, s0, 0xc0000f
    s_cmp_gt_u32 s0, s54
    s_cbranch_scc1 Lpk_153
    s_mov_b32 m0, s26
    s_add_u32 s0, s16, s101
    s_addc_u32 s1, s17, 0
    s_add_u32 s24, s24, 2
    global_load_lds_dwordx4 v8, s[0:1] nt
    global_load_lds_dwordx4 v9, s[0:1] offset:1024 nt
    s_add_u32 s101, s101, 65536
    s_and_b32 s101, s101, 0x7ffff
    s_add_u32 s26, s26, 2048
    s_and_b32 s0, s24, 15
    s_cbranch_scc0 Lps_154
Lpk_153:
    s_cmp_ge_u32 s24, s25
    s_cbranch_scc1 Lpk_155
    s_getreg_b32 s0, hwreg(HW_REG_IB_STS)
    s_and_b32 s0, s0, 0xc0000f
    s_cmp_gt_u32 s0, s54
    s_cbranch_scc1 Lpk_155
    s_mov_b32 m0, s26
    s_add_u32 s0, s16, s101
    s_addc_u32 s1, s17, 0
    s_add_u32 s24, s24, 2
    global_load_lds_dwordx4 v8, s[0:1] nt
    global_load_lds_dwordx4 v9, s[0:1] offset:1024 nt
    s_add_u32 s101, s101, 65536
    s_and_b32 s101, s101, 0x7ffff
    s_add_u32 s26, s26, 2048
    s_and_b32 s0, s24, 15
    s_cbranch_scc0 Lps_156
Lpk_155:
    s_branch L_att
L_attreg:
    ds_read_b128 v[22:25], v0 offset:0
    ds_read_b128 v[26:29], v0 offset:64
    ds_read_b128 v[30:33], v0 offset:128
    ds_read_b128 v[34:37], v0 offset:192
    v_mov_b32_dpp v62, v0 row_ror:4 row_mask:0xf bank_mask:0xf
    ds_read_b128 v[38:41], v62 offset:0
    ds_read_b128 v[42:45], v62 offset:64
    ds_read_b128 v[46:49], v62 offset:128
    ds_read_b128 v[50:53], v62 offset:192
    s_cmp_ge_u32 s24, s25
    s_cbranch_scc1 Lpk_157
    s_getreg_b32 s0, hwreg(HW_REG_IB_STS)
    s_and_b32 s0, s0, 0xc0000f
    s_cmp_gt_u32 s0, 10
    s_cbranch_scc1 Lpk_157
    s_mov_b32 m0, s26
    s_add_u32 s0, s16, s101
    s_addc_u32 s1, s17, 0
    s_add_u32 s24, s24, 2
    global_load_lds_dwordx4 v8, s[0:1] nt
    global_load_lds_dwordx4 v9, s[0:1] offset:1024 nt
    s_add_u32 s101, s101, 65536
    s_and_b32 s101, s101, 0x7ffff
    s_add_u32 s26, s26, 2048
    s_and_b32 s0, s24, 15
    s_cbranch_scc0 Lps_158
Lpk_157:
    s_cmp_ge_u32 s24, s25
    s_cbranch_scc1 Lpk_159
    s_getreg_b32 s0, hwreg(HW_REG_IB_STS)
    s_and_b32 s0, s0, 0xc0000f
    s_cmp_gt_u32 s0, 10
    s_cbranch_scc1 Lpk_159
    s_mov_b32 m0, s26
    s_add_u32 s0, s16, s101
    s_addc_u32 s1, s17, 0
    s_add_u32 s24, s24, 2
    global_load_lds_dwordx4 v8, s[0:1] nt
    global_load_lds_dwordx4 v9, s[0:1] offset:1024 nt
    s_add_u32 s101, s101, 65536
    s_and_b32 s101, s101, 0x7ffff
    s_add_u32 s26, s26, 2048
    s_and_b32 s0, s24, 15
    s_cbranch_scc0 Lps_160
Lpk_159:
    s_and_b32 s50, s27, 1
    s_mul_i32 s51, s50, 8448
    s_lshl_b32 s49, s50, 4
    s_lshl_b32 s50, s3, 2
    s_add_u32 s49, s49, s50
    s_add_u32 s49, s49, 147968
    s_mul_i32 s48, s27, 86
    s_lshr_b32 s48, s48, 8
    s_mul_i32 s48, s48, 3
    s_sub_u32 s48, s27, s48
    s_cmp_eq_u32 s48, 1
    s_cbranch_scc1 L_qk1
    s_cmp_eq_u32 s48, 2
    s_cbranch_scc1 L_qk2
    s_waitcnt lgkmcnt(7)
    v_mfma_f32_16x16x32_bf16 v[54:57], a[0:3], v[22:25], 0
    s_waitcnt lgkmcnt(6)
    v_mfma_f32_16x16x32_bf16 v[54:57], a[4:7], v[26:29], v[54:57]
    s_waitcnt lgkmcnt(5)
    v_mfma_f32_16x16x32_bf16 v[54:57], a[8:11], v[30:33], v[54:57]
    s_waitcnt lgkmcnt(4)
    v_mfma_f32_16x16x32_bf16 v[54:57], a[12:15], v[34:37], v[54:57]
    v_mov_b32_dpp v62, v0 row_ror:8 row_mask:0xf bank_mask:0xf
    ds_read_b128 v[22:25], v62 offset:0
    ds_read_b128 v[26:29], v62 offset:64
    ds_read_b128 v[30:33], v62 offset:128
    ds_read_b128 v[34:37], v62 offset:192
    s_waitcnt lgkmcnt(7)
    v_mfma_f32_16x16x32_bf16 v[54:57], a[16:19], v[38:41], v[54:57]
    s_waitcnt lgkmcnt(6)
    v_mfma_f32_16x16x32_bf16 v[54:57], a[20:23], v[42:45], v[54:57]
    s_waitcnt lgkmcnt(5)
    v_mfma_f32_16x16x32_bf16 v[54:57], a[24:27], v[46:49], v[54:57]
    s_waitcnt lgkmcnt(4)
    v_mfma_f32_16x16x32_bf16 v[54:57], a[28:31], v[50:53], v[54:57]
    v_mov_b32_dpp v62, v0 row_ror:12 row_mask:0xf bank_mask:0xf
    ds_read_b128 v[38:41], v62 offset:0
    ds_read_b128 v[42:45], v62 offset:64
    ds_read_b128 v[46:49], v62 offset:128
    ds_read_b128 v[50:53], v62 offset:192
    s_waitcnt lgkmcnt(7)
    v_mfma_f32_16x16x32_bf16 v[54:57], a[32:35], v[22:25], v[54:57]
    s_waitcnt lgkmcnt(6)
    v_mfma_f32_16x16x32_bf16 v[54:57], a[36:39], v[26:29], v[54:57]
    s_waitcnt lgkmcnt(5)
    v_mfma_f32_16x16x32_bf16 v[54:57], a[40:43], v[30:33], v[54:57]
    s_waitcnt lgkmcnt(4)
    v_mfma_f32_16x16x32_bf16 v[54:57], a[44:47], v[34:37], v[54:57]
    s_waitcnt lgkmcnt(3)
    v_mfma_f32_16x16x32_bf16 v[54:57], a[48:51], v[38:41], v[54:57]
    s_waitcnt lgkmcnt(2)
    v_mfma_f32_16x16x32_bf16 v[54:57], a[52:55], v[42:45], v[54:57]
    s_waitcnt lgkmcnt(1)
    v_mfma_f32_16x16x32_bf16 v[54:57], a[56:59], v[46:49], v[54:57]
    s_waitcnt lgkmcnt(0)
    v_mfma_f32_16x16x32_bf16 v[54:57], a[60:63], v[50:53], v[54:57]
    s_cmp_ge_u32 s24, s25
    s_cbranch_scc1 Lpk_161
    s_getreg_b32 s0, hwreg(HW_REG_IB_STS)
    s_and_b32 s0, s0, 0xc0000f
    s_cmp_gt_u32 s0, s55
    s_cbranch_scc1 Lpk_161
    s_mov_b32 m0, s26
    s_add_u32 s0, s16, s101
    s_addc_u32 s1, s17, 0
    s_add_u32 s24, s24, 2
    global_load_lds_dwordx4 v8, s[0:1] nt
    global_load_lds_dwordx4 v9, s[0:1] offset:1024 nt
    s_add_u32 s101, s101, 65536
    s_and_b32 s101, s101, 0x7ffff
    s_add_u32 s26, s26, 2048
    s_and_b32 s0, s24, 15
    s_cbranch_scc0 Lps_162
Lpk_161:
    s_cmp_ge_u32 s24, s25
    s_cbranch_scc1 Lpk_163
    s_getreg_b32 s0, hwreg(HW_REG_IB_STS)
    s_and_b32 s0, s0, 0xc0000f
    s_cmp_gt_u32 s0, s55
    s_cbranch_scc1 Lpk_163
    s_mov_b32 m0, s26
    s_add_u32 s0, s16, s101
    s_addc_u32 s1, s17, 0
    s_add_u32 s24, s24, 2
    global_load_lds_dwordx4 v8, s[0:1] nt
    global_load_lds_dwordx4 v9, s[0:1] offset:1024 nt
    s_add_u32 s101, s101, 65536
    s_and_b32 s101, s101, 0x7ffff
    s_add_u32 s26, s26, 2048
    s_and_b32 s0, s24, 15
    s_cbranch_scc0 Lps_164
Lpk_163:
    s_nop 7
    v_max3_f32 v62, v54, v55, v56
    v_max_f32 v62, v62, v57
    s_nop 1
    v_max_f32_dpp v62, v62, v62 row_ror:4 row_mask:0xf bank_mask:0xf
    s_nop 1
    v_max_f32_dpp v62, v62, v62 row_ror:8 row_mask:0xf bank_mask:0xf
    v_mov_b32 v21, v62
    s_nop 1
    v_permlane32_swap_b32 v62, v21
    s_nop 0
    v_max_f32 v62, v62, v21
    v_mov_b32 v21, v62
    s_nop 1
    v_permlane16_swap_b32 v62, v21
    s_nop 0
    v_max_f32 v62, v62, v21
    v_mul_f32 v62, v17, v62
    v_pk_fma_f32 v[54:55], v[54:55], v[16:17], v[62:63] op_sel:[0,1,0] op_sel_hi:[1,1,0] neg_lo:[0,0,1] neg_hi:[0,0,1]
    v_pk_fma_f32 v[56:57], v[56:57], v[16:17], v[62:63] op_sel:[0,1,0] op_sel_hi:[1,1,0] neg_lo:[0,0,1] neg_hi:[0,0,1]
    v_exp_f32 v54, v54
    v_exp_f32 v55, v55
    v_exp_f32 v56, v56
    v_exp_f32 v57, v57
    v_add_f32 v21, v54, v55
    v_add_f32 v21, v21, v56
    v_cvt_pk_bf16_f32 v54, v54, v55
    v_add_f32 v21, v21, v57
    v_cvt_pk_bf16_f32 v55, v56, v57
    v_mov_b32_dpp v56, v54 row_shl:4 row_mask:0xf bank_mask:0xf
    s_nop 0
    v_mov_b32_dpp v57, v55 row_shl:4 row_mask:0xf bank_mask:0xf
    v_mov_b32_dpp v58, v54 row_shl:8 row_mask:0xf bank_mask:0xf
    v_mov_b32_dpp v59, v55 row_shl:8 row_mask:0xf bank_mask:0xf
    v_mov_b32_dpp v60, v54 row_shl:12 row_mask:0xf bank_mask:0xf
    v_mov_b32_dpp v61, v55 row_shl:12 row_mask:0xf bank_mask:0xf
    s_nop 0
    v_mfma_f32_16x16x32_bf16 v[22:25], v[64:67], v[54:57], 0
    v_mfma_f32_16x16x32_bf16 v[22:25], v[96:99], v[58:61], v[22:25]
    v_add_f32_dpp v21, v21, v21 row_ror:4 row_mask:0xf bank_mask:0xf
    v_mfma_f32_16x16x32_bf16 v[26:29], v[68:71], v[54:57], 0
    v_mfma_f32_16x16x32_bf16 v[26:29], v[100:103], v[58:61], v[26:29]
    v_add_f32_dpp v21, v21, v21 row_ror:8 row_mask:0xf bank_mask:0xf
    v_mfma_f32_16x16x32_bf16 v[30:33], v[72:75], v[54:57], 0
    v_mfma_f32_16x16x32_bf16 v[30:33], v[104:107], v[58:61], v[30:33]
    v_mfma_f32_16x16x32_bf16 v[34:37], v[76:79], v[54:57], 0
    v_mfma_f32_16x16x32_bf16 v[34:37], v[108:111], v[58:61], v[34:37]
    v_mfma_f32_16x16x32_bf16 v[38:41], v[80:83], v[54:57], 0
    v_mfma_f32_16x16x32_bf16 v[38:41], v[112:115], v[58:61], v[38:41]
    v_mfma_f32_16x16x32_bf16 v[42:45], v[84:87], v[54:57], 0
    v_mfma_f32_16x16x32_bf16 v[42:45], v[116:119], v[58:61], v[42:45]
    v_mfma_f32_16x16x32_bf16 v[46:49], v[88:91], v[54:57], 0
    v_mfma_f32_16x16x32_bf16 v[46:49], v[120:123], v[58:61], v[46:49]
    v_mfma_f32_16x16x32_bf16 v[50:53], v[92:95], v[54:57], 0
    v_mfma_f32_16x16x32_bf16 v[50:53], v[124:127], v[58:61], v[50:53]
    s_branch L_pvD
L_qk1:
    s_waitcnt lgkmcnt(7)
    v_mfma_f32_16x16x32_bf16 v[54:57], a[64:67], v[22:25], 0
    s_waitcnt lgkmcnt(6)
    v_mfma_f32_16x16x32_bf16 v[54:57], a[68:71], v[26:29], v[54:57]
    s_waitcnt lgkmcnt(5)
    v_mfma_f32_16x16x32_bf16 v[54:57], a[72:75], v[30:33], v[54:57]
    s_waitcnt lgkmcnt(4)
    v_mfma_f32_16x16x32_bf16 v[54:57], a[76:79], v[34:37], v[54:57]
    v_mov_b32_dpp v62, v0 row_ror:8 row_mask:0xf bank_mask:0xf
    ds_read_b128 v[22:25], v62 offset:0
    ds_read_b128 v[26:29], v62 offset:64
    ds_read_b128 v[30:33], v62 offset:128
    ds_read_b128 v[34:37], v62 offset:192
    s_waitcnt lgkmcnt(7)
    v_mfma_f32_16x16x32_bf16 v[54:57], a[80:83], v[38:41], v[54:57]
    s_waitcnt lgkmcnt(6)
    v_mfma_f32_16x16x32_bf16 v[54:57], a[84:87], v[42:45], v[54:57]
    s_waitcnt lgkmcnt(5)
    v_mfma_f32_16x16x32_bf16 v[54:57], a[88:91], v[46:49], v[54:57]
    s_waitcnt lgkmcnt(4)
    v_mfma_f32_16x16x32_bf16 v[54:57], a[92:95], v[50:53], v[54:57]
    v_mov_b32_dpp v62, v0 row_ror:12 row_mask:0xf bank_mask:0xf
    ds_read_b128 v[38:41], v62 offset:0
    ds_read_b128 v[42:45], v62 offset:64
    ds_read_b128 v[46:49], v62 offset:128
    ds_read_b128 v[50:53], v62 offset:192
    s_waitcnt lgkmcnt(7)
    v_mfma_f32_16x16x32_bf16 v[54:57], a[96:99], v[22:25], v[54:57]
    s_waitcnt lgkmcnt(6)
    v_mfma_f32_16x16x32_bf16 v[54:57], a[100:103], v[26:29], v[54:57]
    s_waitcnt lgkmcnt(5)
    v_mfma_f32_16x16x32_bf16 v[54:57], a[104:107], v[30:33], v[54:57]
    s_waitcnt lgkmcnt(4)
    v_mfma_f32_16x16x32_bf16 v[54:57], a[108:111], v[34:37], v[54:57]
    s_waitcnt lgkmcnt(3)
    v_mfma_f32_16x16x32_bf16 v[54:57], a[112:115], v[38:41], v[54:57]
    s_waitcnt lgkmcnt(2)
    v_mfma_f32_16x16x32_bf16 v[54:57], a[116:119], v[42:45], v[54:57]
    s_waitcnt lgkmcnt(1)
    v_mfma_f32_16x16x32_bf16 v[54:57], a[120:123], v[46:49], v[54:57]
    s_waitcnt lgkmcnt(0)
    v_mfma_f32_16x16x32_bf16 v[54:57], a[124:127], v[50:53], v[54:57]
    s_cmp_ge_u32 s24, s25
    s_cbranch_scc1 Lpk_165
    s_getreg_b32 s0, hwreg(HW_REG_IB_STS)
    s_and_b32 s0, s0, 0xc0000f
    s_cmp_gt_u32 s0, s55
    s_cbranch_scc1 Lpk_165
    s_mov_b32 m0, s26
    s_add_u32 s0, s16, s101
    s_addc_u32 s1, s17, 0
    s_add_u32 s24, s24, 2
    global_load_lds_dwordx4 v8, s[0:1] nt
    global_load_lds_dwordx4 v9, s[0:1] offset:1024 nt
    s_add_u32 s101, s101, 65536
    s_and_b32 s101, s101, 0x7ffff
    s_add_u32 s26, s26, 2048
    s_and_b32 s0, s24, 15
    s_cbranch_scc0 Lps_166
Lpk_165:
    s_cmp_ge_u32 s24, s25
    s_cbranch_scc1 Lpk_167
    s_getreg_b32 s0, hwreg(HW_REG_IB_STS)
    s_and_b32 s0, s0, 0xc0000f
    s_cmp_gt_u32 s0, s55
    s_cbranch_scc1 Lpk_167
    s_mov_b32 m0, s26
    s_add_u32 s0, s16, s101
    s_addc_u32 s1, s17, 0
    s_add_u32 s24, s24, 2
    global_load_lds_dwordx4 v8, s[0:1] nt
    global_load_lds_dwordx4 v9, s[0:1] offset:1024 nt
    s_add_u32 s101, s101, 65536
    s_and_b32 s101, s101, 0x7ffff
    s_add_u32 s26, s26, 2048
    s_and_b32 s0, s24, 15
    s_cbranch_scc0 Lps_168
Lpk_167:
    s_nop 7
    v_max3_f32 v62, v54, v55, v56
    v_max_f32 v62, v62, v57
    s_nop 1
    v_max_f32_dpp v62, v62, v62 row_ror:4 row_mask:0xf bank_mask:0xf
    s_nop 1
    v_max_f32_dpp v62, v62, v62 row_ror:8 row_mask:0xf bank_mask:0xf
    v_mov_b32 v21, v62
    s_nop 1
    v_permlane32_swap_b32 v62, v21
    s_nop 0
    v_max_f32 v62, v62, v21
    v_mov_b32 v21, v62
    s_nop 1
    v_permlane16_swap_b32 v62, v21
    s_nop 0
    v_max_f32 v62, v62, v21
    v_mul_f32 v62, v17, v62
    v_pk_fma_f32 v[54:55], v[54:55], v[16:17], v[62:63] op_sel:[0,1,0] op_sel_hi:[1,1,0] neg_lo:[0,0,1] neg_hi:[0,0,1]
    v_pk_fma_f32 v[56:57], v[56:57], v[16:17], v[62:63] op_sel:[0,1,0] op_sel_hi:[1,1,0] neg_lo:[0,0,1] neg_hi:[0,0,1]
    v_exp_f32 v54, v54
    v_exp_f32 v55, v55
    v_exp_f32 v56, v56
    v_exp_f32 v57, v57
    v_add_f32 v21, v54, v55
    v_add_f32 v21, v21, v56
    v_cvt_pk_bf16_f32 v54, v54, v55
    v_add_f32 v21, v21, v57
    v_cvt_pk_bf16_f32 v55, v56, v57
    v_mov_b32_dpp v56, v54 row_shl:4 row_mask:0xf bank_mask:0xf
    s_nop 0
    v_mov_b32_dpp v57, v55 row_shl:4 row_mask:0xf bank_mask:0xf
    v_mov_b32_dpp v58, v54 row_shl:8 row_mask:0xf bank_mask:0xf
    v_mov_b32_dpp v59, v55 row_shl:8 row_mask:0xf bank_mask:0xf
    v_mov_b32_dpp v60, v54 row_shl:12 row_mask:0xf bank_mask:0xf
    v_mov_b32_dpp v61, v55 row_shl:12 row_mask:0xf bank_mask:0xf
    s_nop 0
    v_mfma_f32_16x16x32_bf16 v[22:25], v[128:131], v[54:57], 0
    v_mfma_f32_16x16x32_bf16 v[22:25], v[160:163], v[58:61], v[22:25]
    v_add_f32_dpp v21, v21, v21 row_ror:4 row_mask:0xf bank_mask:0xf
    v_mfma_f32_16x16x32_bf16 v[26:29], v[132:135], v[54:57], 0
    v_mfma_f32_16x16x32_bf16 v[26:29], v[164:167], v[58:61], v[26:29]
    v_add_f32_dpp v21, v21, v21 row_ror:8 row_mask:0xf bank_mask:0xf
    v_mfma_f32_16x16x32_bf16 v[30:33], v[136:139], v[54:57], 0
    v_mfma_f32_16x16x32_bf16 v[30:33], v[168:171], v[58:61], v[30:33]
    v_mfma_f32_16x16x32_bf16 v[34:37], v[140:143], v[54:57], 0
    v_mfma_f32_16x16x32_bf16 v[34:37], v[172:175], v[58:61], v[34:37]
    v_mfma_f32_16x16x32_bf16 v[38:41], v[144:147], v[54:57], 0
    v_mfma_f32_16x16x32_bf16 v[38:41], v[176:179], v[58:61], v[38:41]
    v_mfma_f32_16x16x32_bf16 v[42:45], v[148:151], v[54:57], 0
    v_mfma_f32_16x16x32_bf16 v[42:45], v[180:183], v[58:61], v[42:45]
    v_mfma_f32_16x16x32_bf16 v[46:49], v[152:155], v[54:57], 0
    v_mfma_f32_16x16x32_bf16 v[46:49], v[184:187], v[58:61], v[46:49]
    v_mfma_f32_16x16x32_bf16 v[50:53], v[156:159], v[54:57], 0
    v_mfma_f32_16x16x32_bf16 v[50:53], v[188:191], v[58:61], v[50:53]
    s_branch L_pvD
L_qk2:
    s_waitcnt lgkmcnt(7)
    v_mfma_f32_16x16x32_bf16 v[54:57], a[128:131], v[22:25], 0
    s_waitcnt lgkmcnt(6)
    v_mfma_f32_16x16x32_bf16 v[54:57], a[132:135], v[26:29], v[54:57]
    s_waitcnt lgkmcnt(5)
    v_mfma_f32_16x16x32_bf16 v[54:57], a[136:139], v[30:33], v[54:57]
    s_waitcnt lgkmcnt(4)
    v_mfma_f32_16x16x32_bf16 v[54:57], a[140:143], v[34:37], v[54:57]
    v_mov_b32_dpp v62, v0 row_ror:8 row_mask:0xf bank_mask:0xf
    ds_read_b128 v[22:25], v62 offset:0
    ds_read_b128 v[26:29], v62 offset:64
    ds_read_b128 v[30:33], v62 offset:128
    ds_read_b128 v[34:37], v62 offset:192
    s_waitcnt lgkmcnt(7)
    v_mfma_f32_16x16x32_bf16 v[54:57], a[144:147], v[38:41], v[54:57]
    s_waitcnt lgkmcnt(6)
    v_mfma_f32_16x16x32_bf16 v[54:57], a[148:151], v[42:45], v[54:57]
    s_waitcnt lgkmcnt(5)
    v_mfma_f32_16x16x32_bf16 v[54:57], a[152:155], v[46:49], v[54:57]
    s_waitcnt lgkmcnt(4)
    v_mfma_f32_16x16x32_bf16 v[54:57], a[156:159], v[50:53], v[54:57]
    v_mov_b32_dpp v62, v0 row_ror:12 row_mask:0xf bank_mask:0xf
    ds_read_b128 v[38:41], v62 offset:0
    ds_read_b128 v[42:45], v62 offset:64
    ds_read_b128 v[46:49], v62 offset:128
    ds_read_b128 v[50:53], v62 offset:192
    s_waitcnt lgkmcnt(7)
    v_mfma_f32_16x16x32_bf16 v[54:57], a[160:163], v[22:25], v[54:57]
    s_waitcnt lgkmcnt(6)
    v_mfma_f32_16x16x32_bf16 v[54:57], a[164:167], v[26:29], v[54:57]
    s_waitcnt lgkmcnt(5)
    v_mfma_f32_16x16x32_bf16 v[54:57], a[168:171], v[30:33], v[54:57]
    s_waitcnt lgkmcnt(4)
    v_mfma_f32_16x16x32_bf16 v[54:57], a[172:175], v[34:37], v[54:57]
    s_waitcnt lgkmcnt(3)
    v_mfma_f32_16x16x32_bf16 v[54:57], a[176:179], v[38:41], v[54:57]
    s_waitcnt lgkmcnt(2)
    v_mfma_f32_16x16x32_bf16 v[54:57], a[180:183], v[42:45], v[54:57]
    s_waitcnt lgkmcnt(1)
    v_mfma_f32_16x16x32_bf16 v[54:57], a[184:187], v[46:49], v[54:57]
    s_waitcnt lgkmcnt(0)
    v_mfma_f32_16x16x32_bf16 v[54:57], a[188:191], v[50:53], v[54:57]
    s_cmp_ge_u32 s24, s25
    s_cbranch_scc1 Lpk_169
    s_getreg_b32 s0, hwreg(HW_REG_IB_STS)
    s_and_b32 s0, s0, 0xc0000f
    s_cmp_gt_u32 s0, s55
    s_cbranch_scc1 Lpk_169
    s_mov_b32 m0, s26
    s_add_u32 s0, s16, s101
    s_addc_u32 s1, s17, 0
    s_add_u32 s24, s24, 2
    global_load_lds_dwordx4 v8, s[0:1] nt
    global_load_lds_dwordx4 v9, s[0:1] offset:1024 nt
    s_add_u32 s101, s101, 65536
    s_and_b32 s101, s101, 0x7ffff
    s_add_u32 s26, s26, 2048
    s_and_b32 s0, s24, 15
    s_cbranch_scc0 Lps_170
Lpk_169:
    s_cmp_ge_u32 s24, s25
    s_cbranch_scc1 Lpk_171
    s_getreg_b32 s0, hwreg(HW_REG_IB_STS)
    s_and_b32 s0, s0, 0xc0000f
    s_cmp_gt_u32 s0, s55
    s_cbranch_scc1 Lpk_171
    s_mov_b32 m0, s26
    s_add_u32 s0, s16, s101
    s_addc_u32 s1, s17, 0
    s_add_u32 s24, s24, 2
    global_load_lds_dwordx4 v8, s[0:1] nt
    global_load_lds_dwordx4 v9, s[0:1] offset:1024 nt
    s_add_u32 s101, s101, 65536
    s_and_b32 s101, s101, 0x7ffff
    s_add_u32 s26, s26, 2048
    s_and_b32 s0, s24, 15
    s_cbranch_scc0 Lps_172
Lpk_171:
    s_nop 7
    v_max3_f32 v62, v54, v55, v56
    v_max_f32 v62, v62, v57
    s_nop 1
    v_max_f32_dpp v62, v62, v62 row_ror:4 row_mask:0xf bank_mask:0xf
    s_nop 1
    v_max_f32_dpp v62, v62, v62 row_ror:8 row_mask:0xf bank_mask:0xf
    v_mov_b32 v21, v62
    s_nop 1
    v_permlane32_swap_b32 v62, v21
    s_nop 0
    v_max_f32 v62, v62, v21
    v_mov_b32 v21, v62
    s_nop 1
    v_permlane16_swap_b32 v62, v21
    s_nop 0
    v_max_f32 v62, v62, v21
    v_mul_f32 v62, v17, v62
    v_pk_fma_f32 v[54:55], v[54:55], v[16:17], v[62:63] op_sel:[0,1,0] op_sel_hi:[1,1,0] neg_lo:[0,0,1] neg_hi:[0,0,1]
    v_pk_fma_f32 v[56:57], v[56:57], v[16:17], v[62:63] op_sel:[0,1,0] op_sel_hi:[1,1,0] neg_lo:[0,0,1] neg_hi:[0,0,1]
    v_exp_f32 v54, v54
    v_exp_f32 v55, v55
    v_exp_f32 v56, v56
    v_exp_f32 v57, v57
    v_add_f32 v21, v54, v55
    v_add_f32 v21, v21, v56
    v_cvt_pk_bf16_f32 v54, v54, v55
    v_add_f32 v21, v21, v57
    v_cvt_pk_bf16_f32 v55, v56, v57
    v_mov_b32_dpp v56, v54 row_shl:4 row_mask:0xf bank_mask:0xf
    s_nop 0
    v_mov_b32_dpp v57, v55 row_shl:4 row_mask:0xf bank_mask:0xf
    v_mov_b32_dpp v58, v54 row_shl:8 row_mask:0xf bank_mask:0xf
    v_mov_b32_dpp v59, v55 row_shl:8 row_mask:0xf bank_mask:0xf
    v_mov_b32_dpp v60, v54 row_shl:12 row_mask:0xf bank_mask:0xf
    v_mov_b32_dpp v61, v55 row_shl:12 row_mask:0xf bank_mask:0xf
    s_nop 0
    v_mfma_f32_16x16x32_bf16 v[22:25], v[192:195], v[54:57], 0
    v_mfma_f32_16x16x32_bf16 v[22:25], v[224:227], v[58:61], v[22:25]
    v_add_f32_dpp v21, v21, v21 row_ror:4 row_mask:0xf bank_mask:0xf
    v_mfma_f32_16x16x32_bf16 v[26:29], v[196:199], v[54:57], 0
    v_mfma_f32_16x16x32_bf16 v[26:29], v[228:231], v[58:61], v[26:29]
    v_add_f32_dpp v21, v21, v21 row_ror:8 row_mask:0xf bank_mask:0xf
    v_mfma_f32_16x16x32_bf16 v[30:33], v[200:203], v[54:57], 0
    v_mfma_f32_16x16x32_bf16 v[30:33], v[232:235], v[58:61], v[30:33]
    v_mfma_f32_16x16x32_bf16 v[34:37], v[204:207], v[54:57], 0
    v_mfma_f32_16x16x32_bf16 v[34:37], v[236:239], v[58:61], v[34:37]
    v_mfma_f32_16x16x32_bf16 v[38:41], v[208:211], v[54:57], 0
    v_mfma_f32_16x16x32_bf16 v[38:41], v[240:243], v[58:61], v[38:41]
    v_mfma_f32_16x16x32_bf16 v[42:45], v[212:215], v[54:57], 0
    v_mfma_f32_16x16x32_bf16 v[42:45], v[244:247], v[58:61], v[42:45]
    v_mfma_f32_16x16x32_bf16 v[46:49], v[216:219], v[54:57], 0
    v_mfma_f32_16x16x32_bf16 v[46:49], v[248:251], v[58:61], v[46:49]
    v_mfma_f32_16x16x32_bf16 v[50:53], v[220:223], v[54:57], 0
    v_mfma_f32_16x16x32_bf16 v[50:53], v[252:255], v[58:61], v[50:53]
L_pvD:
    v_add_u32 v54, s51, v13
    v_mov_b32 v55, v21
    s_mov_b64 exec, s[98:99]
    ds_write_b128 v54, v[22:25] offset:0
    ds_write_b128 v54, v[26:29] offset:64
    ds_write_b128 v54, v[30:33] offset:128
    ds_write_b128 v54, v[34:37] offset:192
    ds_write_b128 v54, v[38:41] offset:256
    s_mov_b64 exec, -1
    v_permlane32_swap_b32 v21, v55
    v_lshlrev_b32 v56, 6, v1
    v_add_f32 v21, v21, v55
    v_add_u32 v56, s49, v56
    v_mov_b32 v55, v21
    s_mov_b64 exec, s[98:99]
    ds_write_b128 v54, v[42:45] offset:320
    ds_write_b128 v54, v[46:49] offset:384
    ds_write_b128 v54, v[50:53] offset:448
    s_mov_b64 exec, -1
    v_permlane16_swap_b32 v21, v55
    s_nop 0
    v_add_f32 v21, v21, v55
    s_mov_b64 exec, 15
    ds_write_b32 v56, v62
    ds_write_b32 v56, v21 offset:32
    s_mov_b64 exec, -1
    s_setpc_b64 s[60:61]
L_attlds:
    s_branch L_attw
Lps_2:
    s_call_b64 s[58:59], L_seg
    s_branch Lpk_1
Lps_4:
    s_call_b64 s[58:59], L_seg
    s_branch Lpk_3
Lps_6:
    s_call_b64 s[58:59], L_seg
    s_branch Lpk_5
Lps_8:
    s_call_b64 s[58:59], L_seg
    s_branch Lpk_7
Lps_10:
    s_call_b64 s[58:59], L_seg
    s_branch Lpk_9
Lps_12:
    s_call_b64 s[58:59], L_seg
    s_branch Lpk_11
Lps_14:
    s_call_b64 s[58:59], L_seg
    s_branch Lpk_13
Lps_16:
    s_call_b64 s[58:59], L_seg
    s_branch Lpk_15
Lps_18:
    s_call_b64 s[58:59], L_seg
    s_branch Lpk_17
Lps_20:
    s_call_b64 s[58:59], L_seg
    s_branch Lpk_19
Lps_22:
    s_call_b64 s[58:59], L_seg
    s_branch Lpk_21
Lps_24:
    s_call_b64 s[58:59], L_seg
    s_branch Lpk_23
Lps_26:
    s_call_b64 s[58:59], L_seg
    s_branch Lpk_25
Lps_28:
    s_call_b64 s[58:59], L_seg
    s_branch Lpk_27
Lps_30:
    s_call_b64 s[58:59], L_seg
    s_branch Lpk_29
Lps_32:
    s_call_b64 s[58:59], L_seg
    s_branch Lpk_31
Lps_34:
    s_call_b64 s[58:59], L_seg
    s_branch Lpk_33
Lps_36:
    s_call_b64 s[58:59], L_seg
    s_branch Lpk_35
Lps_38:
    s_call_b64 s[58:59], L_seg
    s_branch Lpk_37
Lps_40:
    s_call_b64 s[58:59], L_seg
    s_branch Lpk_39
Lps_42:
    s_call_b64 s[58:59], L_seg
    s_branch Lpk_41
Lps_44:
    s_call_b64 s[58:59], L_seg
    s_branch Lpk_43
Lps_46:
    s_call_b64 s[58:59], L_seg
    s_branch Lpk_45
L_e4:
    s_mov_b32 s54, 8
    s_mov_b32 s55, 8
    s_mov_b32 s56, 5
    s_cmp_le_u32 s35, 4
    s_cbranch_scc1 L_stq
    v_add_u32 v0, 1344, v0
    v_mov_b32 v19, v17
    v_mov_b32 v17, v18
    s_mov_b32 s27, 4
    s_mov_b32 s28, 4
    s_call_b64 s[60:61], L_att
    v_subrev_u32 v0, 1344, v0
    v_mov_b32 v17, v19
    s_mov_b32 s27, 2
    s_mov_b32 s28, 3
    s_mov_b32 s91, 1
    s_mov_b32 s50, 148224
    s_branch L_stq
L_first:
    s_bitcmp0_b32 s28, 0
    s_cbranch_scc1 L_noq
    s_cmp_eq_u32 s28, 1
    s_cselect_b32 s39, 13, 9
    s_cselect_b32 s94, 1, 2
    s_branch L_stq
L_noq:
    s_cmp_eq_u32 s28, 0
    s_cselect_b32 s48, 0, 1344
    s_cselect_b32 s94, 1, 2
    v_add_u32 v0, s48, v0
    s_cbranch_scc1 L_seq
    v_mov_b32 v17, v18
    s_branch L_seq
Ldl_47:
    s_branch Ldb_48
L_cs1:
    s_lshl_b32 s48, s4, 14
    s_lshl_b32 s49, s3, 12
    s_add_u32 s48, s48, s49
    s_and_b32 s49, s39, 1
    s_lshl_b32 s49, s49, 17
    s_add_u32 s48, s48, s49
    s_add_u32 s48, s48, 11534336
    v_lshlrev_b32 v56, 4, v1
    v_add_u32 v56, s48, v56
    global_load_dwordx4 v[38:41], v56, s[6:7] offset:0 sc1
    global_load_dwordx4 v[42:45], v56, s[6:7] offset:1024 sc1
    global_load_dwordx4 v[46:49], v56, s[6:7] offset:2048 sc1
    global_load_dwordx4 v[50:53], v56, s[6:7] offset:3072 sc1
    s_branch L_gC
L_cs2:
    s_waitcnt lgkmcnt(0)
    v_pk_add_f32 v[38:39], v[38:39], v[42:43]
    v_pk_add_f32 v[40:41], v[40:41], v[44:45]
    v_pk_add_f32 v[38:39], v[38:39], v[46:47]
    v_pk_add_f32 v[40:41], v[40:41], v[48:49]
    v_pk_add_f32 v[38:39], v[38:39], v[50:51]
    v_pk_add_f32 v[40:41], v[40:41], v[52:53]
    s_nop 1
    v_permlane32_swap_b32 v38, v40
    v_permlane32_swap_b32 v39, v41
    s_nop 0
    v_pk_add_f32 v[58:59], v[38:39], v[40:41]
    ds_write_b64 v57, v[58:59]
    s_branch L_cs2b
L_eF:
    v_add_f32_dpp v19, v19, v19 quad_perm:[1,0,3,2] row_mask:0xf bank_mask:0xf
    v_mul_f32 v56, v17, v17
    s_nop 0
    v_add_f32_dpp v19, v19, v19 quad_perm:[2,3,0,1] row_mask:0xf bank_mask:0xf
    s_nop 1
    v_add_f32_dpp v19, v19, v19 row_half_mirror row_mask:0xf bank_mask:0xf
    v_mul_f32 v19, 0.001953125, v19
    v_sub_f32 v19, v19, v56
    v_max_f32 v19, 0, v19
    v_cvt_pk_bf16_f32 v19, 0, v19
    v_add_f32 v19, 0x3727c5ac, v19
    v_cvt_pk_bf16_f32 v19, 0, v19
    v_sqrt_f32 v19, v19
    s_nop 0
    v_cvt_pk_bf16_f32 v19, 0, v19
    v_rcp_f32 v19, v19
    s_nop 0
    v_mul_f32 v17, s57, v19
    s_branch L_eFb
Lgs_52:
    s_mov_b32 s41, s24
    s_min_u32 s51, s56, s82
    s_add_u32 s51, s51, 5
    s_min_u32 s51, s51, 13
Lgw_50:
    s_getreg_b32 s0, hwreg(HW_REG_IB_STS)
    s_and_b32 s0, s0, 0xc0000f
    s_sub_u32 s1, s24, s41
    s_cmp_le_u32 s0, s1
    s_cselect_b32 s100, s41, s100
    s_cbranch_scc1 Lgd_51
    s_cmp_ge_u32 s24, s25
    s_cbranch_scc1 Lgv_53
    s_cmp_gt_u32 s0, s51
    s_cbranch_scc1 Lgw_50
    s_mov_b32 m0, s26
    s_add_u32 s0, s16, s101
    s_addc_u32 s1, s17, 0
    s_add_u32 s24, s24, 2
    global_load_lds_dwordx4 v8, s[0:1] nt
    global_load_lds_dwordx4 v9, s[0:1] offset:1024 nt
    s_add_u32 s101, s101, 65536
    s_and_b32 s101, s101, 0x7ffff
    s_add_u32 s26, s26, 2048
    s_and_b32 s0, s24, 15
    s_cbranch_scc0 Lps_54
Lpb_55:
    s_branch Lgw_50
Lgv_53:
    s_call_b64 s[62:63], L_service
    s_branch Lgw_50
Lps_54:
    s_call_b64 s[58:59], L_seg
    s_branch Lpb_55
Ltg_56:
    v_bitop3_b32 v56, v22, v26, v30 bitop3:0x80
    v_bitop3_b32 v56, v56, v34, v54 bitop3:0x80
    v_bitop3_b32 v56, v56, v55, v55 bitop3:0x80
    s_branch Ltb_57
Ltr_58:
    s_mov_b64 exec, vcc
    s_branch L_gC
Lpo_59:
    s_cmp_ge_u32 s24, s25
    s_cbranch_scc1 Lpk_61
    s_getreg_b32 s0, hwreg(HW_REG_IB_STS)
    s_and_b32 s0, s0, 0xc0000f
    s_cmp_gt_u32 s0, 10
    s_cbranch_scc1 Lpk_61
    s_mov_b32 m0, s26
    s_add_u32 s0, s16, s101
    s_addc_u32 s1, s17, 0
    s_add_u32 s24, s24, 2
    global_load_lds_dwordx4 v8, s[0:1] nt
    global_load_lds_dwordx4 v9, s[0:1] offset:1024 nt
    s_add_u32 s101, s101, 65536
    s_and_b32 s101, s101, 0x7ffff
    s_add_u32 s26, s26, 2048
    s_and_b32 s0, s24, 15
    s_cbranch_scc0 Lps_62
Lpk_61:
    s_cmp_ge_u32 s24, s25
    s_cbranch_scc1 Lpk_63
    s_getreg_b32 s0, hwreg(HW_REG_IB_STS)
    s_and_b32 s0, s0, 0xc0000f
    s_cmp_gt_u32 s0, 10
    s_cbranch_scc1 Lpk_63
    s_mov_b32 m0, s26
    s_add_u32 s0, s16, s101
    s_addc_u32 s1, s17, 0
    s_add_u32 s24, s24, 2
    global_load_lds_dwordx4 v8, s[0:1] nt
    global_load_lds_dwordx4 v9, s[0:1] offset:1024 nt
    s_add_u32 s101, s101, 65536
    s_and_b32 s101, s101, 0x7ffff
    s_add_u32 s26, s26, 2048
    s_and_b32 s0, s24, 15
    s_cbranch_scc0 Lps_64
Lpk_63:
    s_cmp_ge_u32 s24, s25
    s_cbranch_scc1 Lpk_65
    s_getreg_b32 s0, hwreg(HW_REG_IB_STS)
    s_and_b32 s0, s0, 0xc0000f
    s_cmp_gt_u32 s0, 10
    s_cbranch_scc1 Lpk_65
    s_mov_b32 m0, s26
    s_add_u32 s0, s16, s101
    s_addc_u32 s1, s17, 0
    s_add_u32 s24, s24, 2
    global_load_lds_dwordx4 v8, s[0:1] nt
    global_load_lds_dwordx4 v9, s[0:1] offset:1024 nt
    s_add_u32 s101, s101, 65536
    s_and_b32 s101, s101, 0x7ffff
    s_add_u32 s26, s26, 2048
    s_and_b32 s0, s24, 15
    s_cbranch_scc0 Lps_66
Lpk_65:
    s_branch Lpr_60
Lps_62:
    s_call_b64 s[58:59], L_seg
    s_branch Lpk_61
Lps_64:
    s_call_b64 s[58:59], L_seg
    s_branch Lpk_63
Lps_66:
    s_call_b64 s[58:59], L_seg
    s_branch Lpk_65
L_m2w:
    s_add_u32 s31, s31, 1
    s_cmp_gt_u32 s31, 1000000
    s_cbranch_scc1 L_done
    s_call_b64 s[62:63], L_service
    s_cmp_ge_u32 s24, s25
    s_cbranch_scc1 Lpk_67
    s_getreg_b32 s0, hwreg(HW_REG_IB_STS)
    s_and_b32 s0, s0, 0xc0000f
    s_cmp_gt_u32 s0, s54
    s_cbranch_scc1 Lpk_67
    s_mov_b32 m0, s26
    s_add_u32 s0, s16, s101
    s_addc_u32 s1, s17, 0
    s_add_u32 s24, s24, 2
    global_load_lds_dwordx4 v8, s[0:1] nt
    global_load_lds_dwordx4 v9, s[0:1] offset:1024 nt
    s_add_u32 s101, s101, 65536
    s_and_b32 s101, s101, 0x7ffff
    s_add_u32 s26, s26, 2048
    s_and_b32 s0, s24, 15
    s_cbranch_scc0 Lps_68
Lpk_67:
    s_branch L_m2
Lps_68:
    s_call_b64 s[58:59], L_seg
    s_branch Lpk_67
L_ek:
    s_mov_b32 s54, 8
    s_mov_b32 s55, 8
    s_mov_b32 s56, 5
    s_mov_b32 s95, 4
    s_mov_b32 s13, 256
    s_call_b64 s[62:63], L_service
    s_branch L_ekb
Lpo_69:
    s_cmp_ge_u32 s24, s25
    s_cbranch_scc1 Lpk_71
    s_getreg_b32 s0, hwreg(HW_REG_IB_STS)
    s_and_b32 s0, s0, 0xc0000f
    s_cmp_gt_u32 s0, s55
    s_cbranch_scc1 Lpk_71
    s_mov_b32 m0, s26
    s_add_u32 s0, s16, s101
    s_addc_u32 s1, s17, 0
    s_add_u32 s24, s24, 2
    global_load_lds_dwordx4 v8, s[0:1] nt
    global_load_lds_dwordx4 v9, s[0:1] offset:1024 nt
    s_add_u32 s101, s101, 65536
    s_and_b32 s101, s101, 0x7ffff
    s_add_u32 s26, s26, 2048
    s_and_b32 s0, s24, 15
    s_cbranch_scc0 Lps_72
Lpk_71:
    s_cmp_ge_u32 s24, s25
    s_cbranch_scc1 Lpk_73
    s_getreg_b32 s0, hwreg(HW_REG_IB_STS)
    s_and_b32 s0, s0, 0xc0000f
    s_cmp_gt_u32 s0, s55
    s_cbranch_scc1 Lpk_73
    s_mov_b32 m0, s26
    s_add_u32 s0, s16, s101
    s_addc_u32 s1, s17, 0
    s_add_u32 s24, s24, 2
    global_load_lds_dwordx4 v8, s[0:1] nt
    global_load_lds_dwordx4 v9, s[0:1] offset:1024 nt
    s_add_u32 s101, s101, 65536
    s_and_b32 s101, s101, 0x7ffff
    s_add_u32 s26, s26, 2048
    s_and_b32 s0, s24, 15
    s_cbranch_scc0 Lps_74
Lpk_73:
    s_branch Lpr_70
Lps_72:
    s_call_b64 s[58:59], L_seg
    s_branch Lpk_71
Lps_74:
    s_call_b64 s[58:59], L_seg
    s_branch Lpk_73
L_a2_1:
    ds_read_b128 v[38:41], v62 offset:0
    ds_read_b128 v[42:45], v62 offset:64
    ds_read_b128 v[46:49], v62 offset:128
    ds_read_b128 v[50:53], v62 offset:192
    s_waitcnt lgkmcnt(7)
    v_mfma_f32_16x16x32_bf16 v[54:57], a[64:67], v[22:25], 0
    s_waitcnt lgkmcnt(6)
    v_mfma_f32_16x16x32_bf16 v[54:57], a[68:71], v[26:29], v[54:57]
    s_waitcnt lgkmcnt(5)
    v_mfma_f32_16x16x32_bf16 v[54:57], a[72:75], v[30:33], v[54:57]
    s_waitcnt lgkmcnt(4)
    v_mfma_f32_16x16x32_bf16 v[54:57], a[76:79], v[34:37], v[54:57]
    v_mov_b32_dpp v62, v0 row_ror:8 row_mask:0xf bank_mask:0xf
    v_mfma_f32_16x16x32_bf16 v[58:61], a[128:131], v[22:25], 0
    ds_read_b128 v[22:25], v62 offset:0
    v_mfma_f32_16x16x32_bf16 v[58:61], a[132:135], v[26:29], v[58:61]
    ds_read_b128 v[26:29], v62 offset:64
    v_mfma_f32_16x16x32_bf16 v[58:61], a[136:139], v[30:33], v[58:61]
    ds_read_b128 v[30:33], v62 offset:128
    v_mfma_f32_16x16x32_bf16 v[58:61], a[140:143], v[34:37], v[58:61]
    ds_read_b128 v[34:37], v62 offset:192
    s_waitcnt lgkmcnt(4)
    v_mfma_f32_16x16x32_bf16 v[54:57], a[80:83], v[38:41], v[54:57]
    v_add_f32_dpp v19, v19, v19 quad_perm:[1,0,3,2] row_mask:0xf bank_mask:0xf
    v_mfma_f32_16x16x32_bf16 v[54:57], a[84:87], v[42:45], v[54:57]
    v_mul_f32 v21, v17, v17
    v_mfma_f32_16x16x32_bf16 v[54:57], a[88:91], v[46:49], v[54:57]
    s_nop 0
    v_add_f32_dpp v19, v19, v19 quad_perm:[2,3,0,1] row_mask:0xf bank_mask:0xf
    v_mfma_f32_16x16x32_bf16 v[54:57], a[92:95], v[50:53], v[54:57]
    v_mov_b32_dpp v62, v0 row_ror:12 row_mask:0xf bank_mask:0xf
    v_mfma_f32_16x16x32_bf16 v[58:61], a[144:147], v[38:41], v[58:61]
    ds_read_b128 v[38:41], v62 offset:0
    v_mfma_f32_16x16x32_bf16 v[58:61], a[148:151], v[42:45], v[58:61]
    ds_read_b128 v[42:45], v62 offset:64
    v_mfma_f32_16x16x32_bf16 v[58:61], a[152:155], v[46:49], v[58:61]
    ds_read_b128 v[46:49], v62 offset:128
    v_mfma_f32_16x16x32_bf16 v[58:61], a[156:159], v[50:53], v[58:61]
    ds_read_b128 v[50:53], v62 offset:192
    s_waitcnt lgkmcnt(4)
    v_mfma_f32_16x16x32_bf16 v[54:57], a[96:99], v[22:25], v[54:57]
    s_nop 1
    v_add_f32_dpp v19, v19, v19 row_half_mirror row_mask:0xf bank_mask:0xf
    v_mfma_f32_16x16x32_bf16 v[54:57], a[100:103], v[26:29], v[54:57]
    v_mul_f32 v19, 0.001953125, v19
    v_mfma_f32_16x16x32_bf16 v[54:57], a[104:107], v[30:33], v[54:57]
    v_sub_f32 v19, v19, v21
    v_mfma_f32_16x16x32_bf16 v[54:57], a[108:111], v[34:37], v[54:57]
    v_max_f32 v19, 0, v19
    v_mfma_f32_16x16x32_bf16 v[58:61], a[160:163], v[22:25], v[58:61]
    v_cvt_pk_bf16_f32 v19, 0, v19
    v_mfma_f32_16x16x32_bf16 v[58:61], a[164:167], v[26:29], v[58:61]
    v_add_f32 v19, 0x3727c5ac, v19
    v_mfma_f32_16x16x32_bf16 v[58:61], a[168:171], v[30:33], v[58:61]
    v_cvt_pk_bf16_f32 v19, 0, v19
    v_mfma_f32_16x16x32_bf16 v[58:61], a[172:175], v[34:37], v[58:61]
    v_sqrt_f32 v19, v19
    s_waitcnt lgkmcnt(0)
    v_mfma_f32_16x16x32_bf16 v[54:57], a[112:115], v[38:41], v[54:57]
    s_nop 0
    v_cvt_pk_bf16_f32 v19, 0, v19
    v_mfma_f32_16x16x32_bf16 v[54:57], a[116:119], v[42:45], v[54:57]
    v_rcp_f32 v19, v19
    v_mfma_f32_16x16x32_bf16 v[54:57], a[120:123], v[46:49], v[54:57]
    s_nop 0
    v_mul_f32 v17, s57, v19
    v_mfma_f32_16x16x32_bf16 v[54:57], a[124:127], v[50:53], v[54:57]
    v_mfma_f32_16x16x32_bf16 v[58:61], a[176:179], v[38:41], v[58:61]
    v_mfma_f32_16x16x32_bf16 v[58:61], a[180:183], v[42:45], v[58:61]
    v_mfma_f32_16x16x32_bf16 v[58:61], a[184:187], v[46:49], v[58:61]
    v_mfma_f32_16x16x32_bf16 v[58:61], a[188:191], v[50:53], v[58:61]
    s_cmp_lt_u32 s24, s25
    s_cbranch_scc1 Lpo_75
Lpr_76:
    s_lshl_b32 s49, s3, 2
    s_add_u32 s49, s49, 147968
    s_nop 1
    v_max3_f32 v62, v54, v55, v56
    s_nop 2
    v_max3_f32 v21, v58, v59, v60
    v_max3_f32 v62, v62, v57, v61
    v_max_f32 v62, v62, v21
    s_nop 1
    v_max_f32_dpp v62, v62, v62 row_ror:4 row_mask:0xf bank_mask:0xf
    s_nop 1
    v_max_f32_dpp v62, v62, v62 row_ror:8 row_mask:0xf bank_mask:0xf
    v_mov_b32 v21, v62
    s_nop 1
    v_permlane32_swap_b32 v62, v21
    s_nop 0
    v_max_f32 v62, v62, v21
    v_mov_b32 v21, v62
    s_nop 1
    v_permlane16_swap_b32 v62, v21
    s_nop 0
    v_max_f32 v62, v62, v21
    v_mul_f32 v62, v17, v62
    v_pk_fma_f32 v[54:55], v[54:55], v[16:17], v[62:63] op_sel:[0,1,0] op_sel_hi:[1,1,0] neg_lo:[0,0,1] neg_hi:[0,0,1]
    v_pk_fma_f32 v[56:57], v[56:57], v[16:17], v[62:63] op_sel:[0,1,0] op_sel_hi:[1,1,0] neg_lo:[0,0,1] neg_hi:[0,0,1]
    v_pk_fma_f32 v[58:59], v[58:59], v[16:17], v[62:63] op_sel:[0,1,0] op_sel_hi:[1,1,0] neg_lo:[0,0,1] neg_hi:[0,0,1]
    v_pk_fma_f32 v[60:61], v[60:61], v[16:17], v[62:63] op_sel:[0,1,0] op_sel_hi:[1,1,0] neg_lo:[0,0,1] neg_hi:[0,0,1]
    v_exp_f32 v54, v54
    v_exp_f32 v55, v55
    v_exp_f32 v56, v56
    v_exp_f32 v57, v57
    v_exp_f32 v58, v58
    v_cvt_pk_bf16_f32 v38, v54, v55
    v_cvt_pk_bf16_f32 v39, v56, v57
    v_exp_f32 v59, v59
    v_mov_b32_dpp v40, v38 row_shl:4 row_mask:0xf bank_mask:0xf
    v_mov_b32_dpp v41, v39 row_shl:4 row_mask:0xf bank_mask:0xf
    v_exp_f32 v60, v60
    v_mov_b32_dpp v42, v38 row_shl:8 row_mask:0xf bank_mask:0xf
    v_mfma_f32_16x16x32_bf16 v[22:25], v[128:131], v[38:41], 0
    v_mov_b32_dpp v43, v39 row_shl:8 row_mask:0xf bank_mask:0xf
    v_mov_b32_dpp v44, v38 row_shl:12 row_mask:0xf bank_mask:0xf
    v_mov_b32_dpp v45, v39 row_shl:12 row_mask:0xf bank_mask:0xf
    v_mfma_f32_16x16x32_bf16 v[26:29], v[132:135], v[38:41], 0
    v_exp_f32 v61, v61
    v_cvt_pk_bf16_f32 v46, v58, v59
    v_mfma_f32_16x16x32_bf16 v[22:25], v[160:163], v[42:45], v[22:25]
    v_cvt_pk_bf16_f32 v47, v60, v61
    v_pk_add_f32 v[54:55], v[54:55], v[56:57]
    v_mov_b32_dpp v48, v46 row_shl:4 row_mask:0xf bank_mask:0xf
    v_mfma_f32_16x16x32_bf16 v[26:29], v[164:167], v[42:45], v[26:29]
    v_mov_b32_dpp v49, v47 row_shl:4 row_mask:0xf bank_mask:0xf
    v_mov_b32_dpp v50, v46 row_shl:8 row_mask:0xf bank_mask:0xf
    v_mov_b32_dpp v51, v47 row_shl:8 row_mask:0xf bank_mask:0xf
    v_mfma_f32_16x16x32_bf16 v[22:25], v[192:195], v[46:49], v[22:25]
    v_mov_b32_dpp v52, v46 row_shl:12 row_mask:0xf bank_mask:0xf
    v_mov_b32_dpp v53, v47 row_shl:12 row_mask:0xf bank_mask:0xf
    v_mfma_f32_16x16x32_bf16 v[26:29], v[196:199], v[46:49], v[26:29]
    v_pk_add_f32 v[58:59], v[58:59], v[60:61]
    v_mfma_f32_16x16x32_bf16 v[22:25], v[224:227], v[50:53], v[22:25]
    v_pk_add_f32 v[54:55], v[54:55], v[58:59]
    v_lshlrev_b32 v61, 6, v1
    v_mfma_f32_16x16x32_bf16 v[26:29], v[228:231], v[50:53], v[26:29]
    v_add_f32 v21, v54, v55
    v_add_u32 v61, s49, v61
    v_mfma_f32_16x16x32_bf16 v[30:33], v[136:139], v[38:41], 0
    s_mov_b64 exec, 15
    ds_write_b32 v61, v62
    s_mov_b64 exec, -1
    v_mfma_f32_16x16x32_bf16 v[30:33], v[168:171], v[42:45], v[30:33]
    v_add_f32_dpp v21, v21, v21 row_ror:4 row_mask:0xf bank_mask:0xf
    v_mfma_f32_16x16x32_bf16 v[30:33], v[200:203], v[46:49], v[30:33]
    v_mov_b32 v62, v61
    v_mfma_f32_16x16x32_bf16 v[30:33], v[232:235], v[50:53], v[30:33]
    v_add_f32_dpp v21, v21, v21 row_ror:8 row_mask:0xf bank_mask:0xf
    v_mfma_f32_16x16x32_bf16 v[34:37], v[140:143], v[38:41], 0
    v_mov_b32 v54, v21
    v_mfma_f32_16x16x32_bf16 v[34:37], v[172:175], v[42:45], v[34:37]
    s_mov_b64 exec, s[98:99]
    ds_write_b128 v13, v[22:25] offset:0
    s_mov_b64 exec, -1
    v_mfma_f32_16x16x32_bf16 v[34:37], v[204:207], v[46:49], v[34:37]
    v_permlane32_swap_b32 v21, v54
    v_mfma_f32_16x16x32_bf16 v[34:37], v[236:239], v[50:53], v[34:37]
    s_mov_b64 exec, s[98:99]
    ds_write_b128 v13, v[26:29] offset:64
    s_mov_b64 exec, -1
    v_add_f32 v21, v21, v54
    v_mfma_f32_16x16x32_bf16 v[54:57], v[144:147], v[38:41], 0
    v_mfma_f32_16x16x32_bf16 v[54:57], v[176:179], v[42:45], v[54:57]
    v_mfma_f32_16x16x32_bf16 v[54:57], v[208:211], v[46:49], v[54:57]
    v_mfma_f32_16x16x32_bf16 v[54:57], v[240:243], v[50:53], v[54:57]
    s_mov_b64 exec, s[98:99]
    ds_write_b128 v13, v[30:33] offset:128
    s_mov_b64 exec, -1
    v_mfma_f32_16x16x32_bf16 v[58:61], v[148:151], v[38:41], 0
    v_mfma_f32_16x16x32_bf16 v[58:61], v[180:183], v[42:45], v[58:61]
    v_mfma_f32_16x16x32_bf16 v[58:61], v[212:215], v[46:49], v[58:61]
    v_mfma_f32_16x16x32_bf16 v[58:61], v[244:247], v[50:53], v[58:61]
    s_mov_b64 exec, s[98:99]
    ds_write_b128 v13, v[34:37] offset:192
    s_mov_b64 exec, -1
    s_waitcnt lgkmcnt(2)
    v_mfma_f32_16x16x32_bf16 v[22:25], v[152:155], v[38:41], 0
    s_mov_b64 exec, s[98:99]
    ds_write_b128 v13, v[54:57] offset:256
    s_mov_b64 exec, -1
    v_mfma_f32_16x16x32_bf16 v[22:25], v[184:187], v[42:45], v[22:25]
    v_mfma_f32_16x16x32_bf16 v[22:25], v[216:219], v[46:49], v[22:25]
    v_mfma_f32_16x16x32_bf16 v[22:25], v[248:251], v[50:53], v[22:25]
    v_mov_b32 v54, v21
    v_mfma_f32_16x16x32_bf16 v[26:29], v[156:159], v[38:41], 0
    v_mfma_f32_16x16x32_bf16 v[26:29], v[188:191], v[42:45], v[26:29]
    v_permlane16_swap_b32 v21, v54
    v_mfma_f32_16x16x32_bf16 v[26:29], v[220:223], v[46:49], v[26:29]
    v_add_f32 v21, v21, v54
    v_mfma_f32_16x16x32_bf16 v[26:29], v[252:255], v[50:53], v[26:29]
    s_mov_b64 exec, s[98:99]
    ds_write_b128 v13, v[58:61] offset:320
    s_mov_b64 exec, -1
    s_mov_b64 exec, 15
    ds_write_b32 v62, v21 offset:32
    s_mov_b64 exec, s[98:99]
    ds_write_b128 v13, v[22:25] offset:384
    s_add_u32 s95, s27, 4
    s_min_u32 s95, s95, 7
    s_nop 0
    s_lshl_b32 s48, s3, 6
    s_add_u32 s48, s48, 147968
    ds_write_b128 v13, v[26:29] offset:448
    s_mov_b64 exec, -1
    v_mov_b32 v54, s48
    v_add_u32 v55, 0, v14
    s_branch L_a2D
Lpo_75:
    s_cmp_ge_u32 s24, s25
    s_cbranch_scc1 Lpk_77
    s_getreg_b32 s0, hwreg(HW_REG_IB_STS)
    s_and_b32 s0, s0, 0xc0000f
    s_cmp_gt_u32 s0, s55
    s_cbranch_scc1 Lpk_77
    s_mov_b32 m0, s26
    s_add_u32 s0, s16, s101
    s_addc_u32 s1, s17, 0
    s_add_u32 s24, s24, 2
    global_load_lds_dwordx4 v8, s[0:1] nt
    global_load_lds_dwordx4 v9, s[0:1] offset:1024 nt
    s_add_u32 s101, s101, 65536
    s_and_b32 s101, s101, 0x7ffff
    s_add_u32 s26, s26, 2048
    s_and_b32 s0, s24, 15
    s_cbranch_scc0 Lps_78
Lpk_77:
    s_cmp_ge_u32 s24, s25
    s_cbranch_scc1 Lpk_79
    s_getreg_b32 s0, hwreg(HW_REG_IB_STS)
    s_and_b32 s0, s0, 0xc0000f
    s_cmp_gt_u32 s0, s55
    s_cbranch_scc1 Lpk_79
    s_mov_b32 m0, s26
    s_add_u32 s0, s16, s101
    s_addc_u32 s1, s17, 0
    s_add_u32 s24, s24, 2
    global_load_lds_dwordx4 v8, s[0:1] nt
    global_load_lds_dwordx4 v9, s[0:1] offset:1024 nt
    s_add_u32 s101, s101, 65536
    s_and_b32 s101, s101, 0x7ffff
    s_add_u32 s26, s26, 2048
    s_and_b32 s0, s24, 15
    s_cbranch_scc0 Lps_80
Lpk_79:
    s_branch Lpr_76
Lps_78:
    s_call_b64 s[58:59], L_seg
    s_branch Lpk_77
Lps_80:
    s_call_b64 s[58:59], L_seg
    s_branch Lpk_79
L_a2_2:
    ds_read_b128 v[38:41], v62 offset:0
    ds_read_b128 v[42:45], v62 offset:64
    ds_read_b128 v[46:49], v62 offset:128
    ds_read_b128 v[50:53], v62 offset:192
    s_waitcnt lgkmcnt(7)
    v_mfma_f32_16x16x32_bf16 v[54:57], a[128:131], v[22:25], 0
    s_waitcnt lgkmcnt(6)
    v_mfma_f32_16x16x32_bf16 v[54:57], a[132:135], v[26:29], v[54:57]
    s_waitcnt lgkmcnt(5)
    v_mfma_f32_16x16x32_bf16 v[54:57], a[136:139], v[30:33], v[54:57]
    s_waitcnt lgkmcnt(4)
    v_mfma_f32_16x16x32_bf16 v[54:57], a[140:143], v[34:37], v[54:57]
    v_mov_b32_dpp v62, v0 row_ror:8 row_mask:0xf bank_mask:0xf
    v_mfma_f32_16x16x32_bf16 v[58:61], a[0:3], v[22:25], 0
    ds_read_b128 v[22:25], v62 offset:0
    v_mfma_f32_16x16x32_bf16 v[58:61], a[4:7], v[26:29], v[58:61]
    ds_read_b128 v[26:29], v62 offset:64
    v_mfma_f32_16x16x32_bf16 v[58:61], a[8:11], v[30:33], v[58:61]
    ds_read_b128 v[30:33], v62 offset:128
    v_mfma_f32_16x16x32_bf16 v[58:61], a[12:15], v[34:37], v[58:61]
    ds_read_b128 v[34:37], v62 offset:192
    s_waitcnt lgkmcnt(4)
    v_mfma_f32_16x16x32_bf16 v[54:57], a[144:147], v[38:41], v[54:57]
    v_add_f32_dpp v19, v19, v19 quad_perm:[1,0,3,2] row_mask:0xf bank_mask:0xf
    v_mfma_f32_16x16x32_bf16 v[54:57], a[148:151], v[42:45], v[54:57]
    v_mul_f32 v21, v17, v17
    v_mfma_f32_16x16x32_bf16 v[54:57], a[152:155], v[46:49], v[54:57]
    s_nop 0
    v_add_f32_dpp v19, v19, v19 quad_perm:[2,3,0,1] row_mask:0xf bank_mask:0xf
    v_mfma_f32_16x16x32_bf16 v[54:57], a[156:159], v[50:53], v[54:57]
    v_mov_b32_dpp v62, v0 row_ror:12 row_mask:0xf bank_mask:0xf
    v_mfma_f32_16x16x32_bf16 v[58:61], a[16:19], v[38:41], v[58:61]
    ds_read_b128 v[38:41], v62 offset:0
    v_mfma_f32_16x16x32_bf16 v[58:61], a[20:23], v[42:45], v[58:61]
    ds_read_b128 v[42:45], v62 offset:64
    v_mfma_f32_16x16x32_bf16 v[58:61], a[24:27], v[46:49], v[58:61]
    ds_read_b128 v[46:49], v62 offset:128
    v_mfma_f32_16x16x32_bf16 v[58:61], a[28:31], v[50:53], v[58:61]
    ds_read_b128 v[50:53], v62 offset:192
    s_waitcnt lgkmcnt(4)
    v_mfma_f32_16x16x32_bf16 v[54:57], a[160:163], v[22:25], v[54:57]
    s_nop 1
    v_add_f32_dpp v19, v19, v19 row_half_mirror row_mask:0xf bank_mask:0xf
    v_mfma_f32_16x16x32_bf16 v[54:57], a[164:167], v[26:29], v[54:57]
    v_mul_f32 v19, 0.001953125, v19
    v_mfma_f32_16x16x32_bf16 v[54:57], a[168:171], v[30:33], v[54:57]
    v_sub_f32 v19, v19, v21
    v_mfma_f32_16x16x32_bf16 v[54:57], a[172:175], v[34:37], v[54:57]
    v_max_f32 v19, 0, v19
    v_mfma_f32_16x16x32_bf16 v[58:61], a[32:35], v[22:25], v[58:61]
    v_cvt_pk_bf16_f32 v19, 0, v19
    v_mfma_f32_16x16x32_bf16 v[58:61], a[36:39], v[26:29], v[58:61]
    v_add_f32 v19, 0x3727c5ac, v19
    v_mfma_f32_16x16x32_bf16 v[58:61], a[40:43], v[30:33], v[58:61]
    v_cvt_pk_bf16_f32 v19, 0, v19
    v_mfma_f32_16x16x32_bf16 v[58:61], a[44:47], v[34:37], v[58:61]
    v_sqrt_f32 v19, v19
    s_waitcnt lgkmcnt(0)
    v_mfma_f32_16x16x32_bf16 v[54:57], a[176:179], v[38:41], v[54:57]
    s_nop 0
    v_cvt_pk_bf16_f32 v19, 0, v19
    v_mfma_f32_16x16x32_bf16 v[54:57], a[180:183], v[42:45], v[54:57]
    v_rcp_f32 v19, v19
    v_mfma_f32_16x16x32_bf16 v[54:57], a[184:187], v[46:49], v[54:57]
    s_nop 0
    v_mul_f32 v17, s57, v19
    v_mfma_f32_16x16x32_bf16 v[54:57], a[188:191], v[50:53], v[54:57]
    v_mfma_f32_16x16x32_bf16 v[58:61], a[48:51], v[38:41], v[58:61]
    v_mfma_f32_16x16x32_bf16 v[58:61], a[52:55], v[42:45], v[58:61]
    v_mfma_f32_16x16x32_bf16 v[58:61], a[56:59], v[46:49], v[58:61]
    v_mfma_f32_16x16x32_bf16 v[58:61], a[60:63], v[50:53], v[58:61]
    s_cmp_lt_u32 s24, s25
    s_cbranch_scc1 Lpo_81
Lpr_82:
    s_lshl_b32 s49, s3, 2
    s_add_u32 s49, s49, 147984
    s_nop 1
    v_max3_f32 v62, v54, v55, v56
    s_nop 2
    v_max3_f32 v21, v58, v59, v60
    v_max3_f32 v62, v62, v57, v61
    v_max_f32 v62, v62, v21
    s_nop 1
    v_max_f32_dpp v62, v62, v62 row_ror:4 row_mask:0xf bank_mask:0xf
    s_nop 1
    v_max_f32_dpp v62, v62, v62 row_ror:8 row_mask:0xf bank_mask:0xf
    v_mov_b32 v21, v62
    s_nop 1
    v_permlane32_swap_b32 v62, v21
    s_nop 0
    v_max_f32 v62, v62, v21
    v_mov_b32 v21, v62
    s_nop 1
    v_permlane16_swap_b32 v62, v21
    s_nop 0
    v_max_f32 v62, v62, v21
    v_mul_f32 v62, v17, v62
    v_pk_fma_f32 v[54:55], v[54:55], v[16:17], v[62:63] op_sel:[0,1,0] op_sel_hi:[1,1,0] neg_lo:[0,0,1] neg_hi:[0,0,1]
    v_pk_fma_f32 v[56:57], v[56:57], v[16:17], v[62:63] op_sel:[0,1,0] op_sel_hi:[1,1,0] neg_lo:[0,0,1] neg_hi:[0,0,1]
    v_pk_fma_f32 v[58:59], v[58:59], v[16:17], v[62:63] op_sel:[0,1,0] op_sel_hi:[1,1,0] neg_lo:[0,0,1] neg_hi:[0,0,1]
    v_pk_fma_f32 v[60:61], v[60:61], v[16:17], v[62:63] op_sel:[0,1,0] op_sel_hi:[1,1,0] neg_lo:[0,0,1] neg_hi:[0,0,1]
    v_exp_f32 v54, v54
    v_exp_f32 v55, v55
    v_exp_f32 v56, v56
    v_exp_f32 v57, v57
    v_exp_f32 v58, v58
    v_cvt_pk_bf16_f32 v38, v54, v55
    v_cvt_pk_bf16_f32 v39, v56, v57
    v_exp_f32 v59, v59
    v_mov_b32_dpp v40, v38 row_shl:4 row_mask:0xf bank_mask:0xf
    v_mov_b32_dpp v41, v39 row_shl:4 row_mask:0xf bank_mask:0xf
    v_exp_f32 v60, v60
    v_mov_b32_dpp v42, v38 row_shl:8 row_mask:0xf bank_mask:0xf
    v_mfma_f32_16x16x32_bf16 v[22:25], v[192:195], v[38:41], 0
    v_mov_b32_dpp v43, v39 row_shl:8 row_mask:0xf bank_mask:0xf
    v_mov_b32_dpp v44, v38 row_shl:12 row_mask:0xf bank_mask:0xf
    v_mov_b32_dpp v45, v39 row_shl:12 row_mask:0xf bank_mask:0xf
    v_mfma_f32_16x16x32_bf16 v[26:29], v[196:199], v[38:41], 0
    v_exp_f32 v61, v61
    v_cvt_pk_bf16_f32 v46, v58, v59
    v_mfma_f32_16x16x32_bf16 v[22:25], v[224:227], v[42:45], v[22:25]
    v_cvt_pk_bf16_f32 v47, v60, v61
    v_pk_add_f32 v[54:55], v[54:55], v[56:57]
    v_mov_b32_dpp v48, v46 row_shl:4 row_mask:0xf bank_mask:0xf
    v_mfma_f32_16x16x32_bf16 v[26:29], v[228:231], v[42:45], v[26:29]
    v_mov_b32_dpp v49, v47 row_shl:4 row_mask:0xf bank_mask:0xf
    v_mov_b32_dpp v50, v46 row_shl:8 row_mask:0xf bank_mask:0xf
    v_mov_b32_dpp v51, v47 row_shl:8 row_mask:0xf bank_mask:0xf
    v_mfma_f32_16x16x32_bf16 v[22:25], v[64:67], v[46:49], v[22:25]
    v_mov_b32_dpp v52, v46 row_shl:12 row_mask:0xf bank_mask:0xf
    v_mov_b32_dpp v53, v47 row_shl:12 row_mask:0xf bank_mask:0xf
    v_mfma_f32_16x16x32_bf16 v[26:29], v[68:71], v[46:49], v[26:29]
    v_pk_add_f32 v[58:59], v[58:59], v[60:61]
    v_mfma_f32_16x16x32_bf16 v[22:25], v[96:99], v[50:53], v[22:25]
    v_pk_add_f32 v[54:55], v[54:55], v[58:59]
    v_lshlrev_b32 v61, 6, v1
    v_mfma_f32_16x16x32_bf16 v[26:29], v[100:103], v[50:53], v[26:29]
    v_add_f32 v21, v54, v55
    v_add_u32 v61, s49, v61
    v_mfma_f32_16x16x32_bf16 v[30:33], v[200:203], v[38:41], 0
    s_mov_b64 exec, 15
    ds_write_b32 v61, v62
    s_mov_b64 exec, -1
    v_mfma_f32_16x16x32_bf16 v[30:33], v[232:235], v[42:45], v[30:33]
    v_add_f32_dpp v21, v21, v21 row_ror:4 row_mask:0xf bank_mask:0xf
    v_mfma_f32_16x16x32_bf16 v[30:33], v[72:75], v[46:49], v[30:33]
    v_mov_b32 v62, v61
    v_mfma_f32_16x16x32_bf16 v[30:33], v[104:107], v[50:53], v[30:33]
    v_add_f32_dpp v21, v21, v21 row_ror:8 row_mask:0xf bank_mask:0xf
    v_mfma_f32_16x16x32_bf16 v[34:37], v[204:207], v[38:41], 0
    v_mov_b32 v54, v21
    v_mfma_f32_16x16x32_bf16 v[34:37], v[236:239], v[42:45], v[34:37]
    s_mov_b64 exec, s[98:99]
    ds_write_b128 v13, v[22:25] offset:8448
    s_mov_b64 exec, -1
    v_mfma_f32_16x16x32_bf16 v[34:37], v[76:79], v[46:49], v[34:37]
    v_permlane32_swap_b32 v21, v54
    v_mfma_f32_16x16x32_bf16 v[34:37], v[108:111], v[50:53], v[34:37]
    s_mov_b64 exec, s[98:99]
    ds_write_b128 v13, v[26:29] offset:8512
    s_mov_b64 exec, -1
    v_add_f32 v21, v21, v54
    v_mfma_f32_16x16x32_bf16 v[54:57], v[208:211], v[38:41], 0
    v_mfma_f32_16x16x32_bf16 v[54:57], v[240:243], v[42:45], v[54:57]
    v_mfma_f32_16x16x32_bf16 v[54:57], v[80:83], v[46:49], v[54:57]
    v_mfma_f32_16x16x32_bf16 v[54:57], v[112:115], v[50:53], v[54:57]
    s_mov_b64 exec, s[98:99]
    ds_write_b128 v13, v[30:33] offset:8576
    s_mov_b64 exec, -1
    v_mfma_f32_16x16x32_bf16 v[58:61], v[212:215], v[38:41], 0
    v_mfma_f32_16x16x32_bf16 v[58:61], v[244:247], v[42:45], v[58:61]
    v_mfma_f32_16x16x32_bf16 v[58:61], v[84:87], v[46:49], v[58:61]
    v_mfma_f32_16x16x32_bf16 v[58:61], v[116:119], v[50:53], v[58:61]
    s_mov_b64 exec, s[98:99]
    ds_write_b128 v13, v[34:37] offset:8640
    s_mov_b64 exec, -1
    s_waitcnt lgkmcnt(2)
    v_mfma_f32_16x16x32_bf16 v[22:25], v[216:219], v[38:41], 0
    s_mov_b64 exec, s[98:99]
    ds_write_b128 v13, v[54:57] offset:8704
    s_mov_b64 exec, -1
    v_mfma_f32_16x16x32_bf16 v[22:25], v[248:251], v[42:45], v[22:25]
    v_mfma_f32_16x16x32_bf16 v[22:25], v[88:91], v[46:49], v[22:25]
    v_mfma_f32_16x16x32_bf16 v[22:25], v[120:123], v[50:53], v[22:25]
    v_mov_b32 v54, v21
    v_mfma_f32_16x16x32_bf16 v[26:29], v[220:223], v[38:41], 0
    v_mfma_f32_16x16x32_bf16 v[26:29], v[252:255], v[42:45], v[26:29]
    v_permlane16_swap_b32 v21, v54
    v_mfma_f32_16x16x32_bf16 v[26:29], v[92:95], v[46:49], v[26:29]
    v_add_f32 v21, v21, v54
    v_mfma_f32_16x16x32_bf16 v[26:29], v[124:127], v[50:53], v[26:29]
    s_mov_b64 exec, s[98:99]
    ds_write_b128 v13, v[58:61] offset:8768
    s_mov_b64 exec, -1
    s_mov_b64 exec, 15
    ds_write_b32 v62, v21 offset:32
    s_mov_b64 exec, s[98:99]
    ds_write_b128 v13, v[22:25] offset:8832
    s_add_u32 s95, s27, 4
    s_min_u32 s95, s95, 7
    s_nop 0
    s_lshl_b32 s48, s3, 6
    s_add_u32 s48, s48, 147984
    ds_write_b128 v13, v[26:29] offset:8896
    s_mov_b64 exec, -1
    v_mov_b32 v54, s48
    v_add_u32 v55, 8448, v14
    s_branch L_a2D
Lpo_81:
    s_cmp_ge_u32 s24, s25
    s_cbranch_scc1 Lpk_83
    s_getreg_b32 s0, hwreg(HW_REG_IB_STS)
    s_and_b32 s0, s0, 0xc0000f
    s_cmp_gt_u32 s0, s55
    s_cbranch_scc1 Lpk_83
    s_mov_b32 m0, s26
    s_add_u32 s0, s16, s101
    s_addc_u32 s1, s17, 0
    s_add_u32 s24, s24, 2
    global_load_lds_dwordx4 v8, s[0:1] nt
    global_load_lds_dwordx4 v9, s[0:1] offset:1024 nt
    s_add_u32 s101, s101, 65536
    s_and_b32 s101, s101, 0x7ffff
    s_add_u32 s26, s26, 2048
    s_and_b32 s0, s24, 15
    s_cbranch_scc0 Lps_84
Lpk_83:
    s_cmp_ge_u32 s24, s25
    s_cbranch_scc1 Lpk_85
    s_getreg_b32 s0, hwreg(HW_REG_IB_STS)
    s_and_b32 s0, s0, 0xc0000f
    s_cmp_gt_u32 s0, s55
    s_cbranch_scc1 Lpk_85
    s_mov_b32 m0, s26
    s_add_u32 s0, s16, s101
    s_addc_u32 s1, s17, 0
    s_add_u32 s24, s24, 2
    global_load_lds_dwordx4 v8, s[0:1] nt
    global_load_lds_dwordx4 v9, s[0:1] offset:1024 nt
    s_add_u32 s101, s101, 65536
    s_and_b32 s101, s101, 0x7ffff
    s_add_u32 s26, s26, 2048
    s_and_b32 s0, s24, 15
    s_cbranch_scc0 Lps_86
Lpk_85:
    s_branch Lpr_82
Lps_84:
    s_call_b64 s[58:59], L_seg
    s_branch Lpk_83
Lps_86:
    s_call_b64 s[58:59], L_seg
    s_branch Lpk_85
L_a2S:
    s_mov_b32 s36, s95
    s_call_b64 s[62:63], L_service
    s_cmp_ge_u32 s24, s25
    s_cbranch_scc1 Lpk_87
    s_getreg_b32 s0, hwreg(HW_REG_IB_STS)
    s_and_b32 s0, s0, 0xc0000f
    s_cmp_gt_u32 s0, s55
    s_cbranch_scc1 Lpk_87
    s_mov_b32 m0, s26
    s_add_u32 s0, s16, s101
    s_addc_u32 s1, s17, 0
    s_add_u32 s24, s24, 2
    global_load_lds_dwordx4 v8, s[0:1] nt
    global_load_lds_dwordx4 v9, s[0:1] offset:1024 nt
    s_add_u32 s101, s101, 65536
    s_and_b32 s101, s101, 0x7ffff
    s_add_u32 s26, s26, 2048
    s_and_b32 s0, s24, 15
    s_cbranch_scc0 Lps_88
Lpk_87:
    s_cmp_ge_u32 s24, s25
    s_cbranch_scc1 Lpk_89
    s_getreg_b32 s0, hwreg(HW_REG_IB_STS)
    s_and_b32 s0, s0, 0xc0000f
    s_cmp_gt_u32 s0, s55
    s_cbranch_scc1 Lpk_89
    s_mov_b32 m0, s26
    s_add_u32 s0, s16, s101
    s_addc_u32 s1, s17, 0
    s_add_u32 s24, s24, 2
    global_load_lds_dwordx4 v8, s[0:1] nt
    global_load_lds_dwordx4 v9, s[0:1] offset:1024 nt
    s_add_u32 s101, s101, 65536
    s_and_b32 s101, s101, 0x7ffff
    s_add_u32 s26, s26, 2048
    s_and_b32 s0, s24, 15
    s_cbranch_scc0 Lps_90
Lpk_89:
    s_branch L_a2Sb
Lps_88:
    s_call_b64 s[58:59], L_seg
    s_branch Lpk_87
Lps_90:
    s_call_b64 s[58:59], L_seg
    s_branch Lpk_89
Lsm_91:
    global_store_dwordx2 v3, v[22:23], s[32:33] sc1
    s_mov_b64 exec, 1
    global_store_dwordx2 v57, v[42:43], s[32:33] sc1
    s_branch Lsb_92
L_a2l:
    s_cmp_le_u32 s35, s27
    s_cbranch_scc1 L_a2lx
    s_lshl_b32 s48, s27, 5
    s_add_u32 s48, s48, 48
    s_cmp_lt_u32 s100, s48
    s_cbranch_scc1 L_a2ly
L_a2lgo:
    s_cmp_eq_u32 s27, 2
    s_cbranch_scc1 L_a2l2
    ds_read_b128 v[22:25], v0
    ds_read_b128 v[38:41], v10
    ds_read_b128 v[26:29], v0 offset:64
    v_xor_b32 v21, 64, v10
    ds_read_b128 v[42:45], v21
    ds_read_b128 v[30:33], v0 offset:128
    v_xor_b32 v21, 128, v10
    ds_read_b128 v[46:49], v21
    ds_read_b128 v[34:37], v0 offset:192
    v_xor_b32 v21, 192, v10
    ds_read_b128 v[50:53], v21
    v_mov_b32_dpp v62, v0 row_ror:4 row_mask:0xf bank_mask:0xf
    s_waitcnt lgkmcnt(6)
    v_mfma_f32_16x16x32_bf16 v[54:57], a[0:3], v[22:25], 0
    v_mfma_f32_16x16x32_bf16 v[58:61], v[38:41], v[22:25], 0
    ds_read_b128 v[22:25], v62 offset:0
    ds_read_b128 v[38:41], v10 offset:4096
    s_waitcnt lgkmcnt(6)
    v_mfma_f32_16x16x32_bf16 v[54:57], a[4:7], v[26:29], v[54:57]
    v_xor_b32 v21, 64, v10
    v_mfma_f32_16x16x32_bf16 v[58:61], v[42:45], v[26:29], v[58:61]
    ds_read_b128 v[26:29], v62 offset:64
    ds_read_b128 v[42:45], v21 offset:4096
    s_waitcnt lgkmcnt(6)
    v_mfma_f32_16x16x32_bf16 v[54:57], a[8:11], v[30:33], v[54:57]
    v_xor_b32 v21, 128, v10
    v_mfma_f32_16x16x32_bf16 v[58:61], v[46:49], v[30:33], v[58:61]
    ds_read_b128 v[30:33], v62 offset:128
    ds_read_b128 v[46:49], v21 offset:4096
    s_waitcnt lgkmcnt(6)
    v_mfma_f32_16x16x32_bf16 v[54:57], a[12:15], v[34:37], v[54:57]
    v_xor_b32 v21, 192, v10
    v_mfma_f32_16x16x32_bf16 v[58:61], v[50:53], v[34:37], v[58:61]
    ds_read_b128 v[34:37], v62 offset:192
    ds_read_b128 v[50:53], v21 offset:4096
    v_mov_b32_dpp v62, v0 row_ror:8 row_mask:0xf bank_mask:0xf
    s_waitcnt lgkmcnt(6)
    v_mfma_f32_16x16x32_bf16 v[54:57], a[16:19], v[22:25], v[54:57]
    v_mfma_f32_16x16x32_bf16 v[58:61], v[38:41], v[22:25], v[58:61]
    ds_read_b128 v[22:25], v62 offset:0
    ds_read_b128 v[38:41], v10 offset:8192
    s_waitcnt lgkmcnt(6)
    v_mfma_f32_16x16x32_bf16 v[54:57], a[20:23], v[26:29], v[54:57]
    v_xor_b32 v21, 64, v10
    v_mfma_f32_16x16x32_bf16 v[58:61], v[42:45], v[26:29], v[58:61]
    ds_read_b128 v[26:29], v62 offset:64
    ds_read_b128 v[42:45], v21 offset:8192
    s_waitcnt lgkmcnt(6)
    v_mfma_f32_16x16x32_bf16 v[54:57], a[24:27], v[30:33], v[54:57]
    v_xor_b32 v21, 128, v10
    v_mfma_f32_16x16x32_bf16 v[58:61], v[46:49], v[30:33], v[58:61]
    ds_read_b128 v[30:33], v62 offset:128
    ds_read_b128 v[46:49], v21 offset:8192
    s_waitcnt lgkmcnt(6)
    v_mfma_f32_16x16x32_bf16 v[54:57], a[28:31], v[34:37], v[54:57]
    v_xor_b32 v21, 192, v10
    v_mfma_f32_16x16x32_bf16 v[58:61], v[50:53], v[34:37], v[58:61]
    ds_read_b128 v[34:37], v62 offset:192
    ds_read_b128 v[50:53], v21 offset:8192
    v_mov_b32_dpp v62, v0 row_ror:12 row_mask:0xf bank_mask:0xf
    s_waitcnt lgkmcnt(6)
    v_mfma_f32_16x16x32_bf16 v[54:57], a[32:35], v[22:25], v[54:57]
    v_mfma_f32_16x16x32_bf16 v[58:61], v[38:41], v[22:25], v[58:61]
    ds_read_b128 v[22:25], v62 offset:0
    ds_read_b128 v[38:41], v10 offset:12288
    s_waitcnt lgkmcnt(6)
    v_mfma_f32_16x16x32_bf16 v[54:57], a[36:39], v[26:29], v[54:57]
    v_xor_b32 v21, 64, v10
    v_mfma_f32_16x16x32_bf16 v[58:61], v[42:45], v[26:29], v[58:61]
    ds_read_b128 v[26:29], v62 offset:64
    ds_read_b128 v[42:45], v21 offset:12288
    s_waitcnt lgkmcnt(6)
    v_mfma_f32_16x16x32_bf16 v[54:57], a[40:43], v[30:33], v[54:57]
    v_xor_b32 v21, 128, v10
    v_mfma_f32_16x16x32_bf16 v[58:61], v[46:49], v[30:33], v[58:61]
    ds_read_b128 v[30:33], v62 offset:128
    ds_read_b128 v[46:49], v21 offset:12288
    s_waitcnt lgkmcnt(6)
    v_mfma_f32_16x16x32_bf16 v[54:57], a[44:47], v[34:37], v[54:57]
    v_xor_b32 v21, 192, v10
    v_mfma_f32_16x16x32_bf16 v[58:61], v[50:53], v[34:37], v[58:61]
    ds_read_b128 v[34:37], v62 offset:192
    ds_read_b128 v[50:53], v21 offset:12288
    s_waitcnt lgkmcnt(6)
    v_mfma_f32_16x16x32_bf16 v[54:57], a[48:51], v[22:25], v[54:57]
    v_mfma_f32_16x16x32_bf16 v[58:61], v[38:41], v[22:25], v[58:61]
    s_waitcnt lgkmcnt(4)
    v_mfma_f32_16x16x32_bf16 v[54:57], a[52:55], v[26:29], v[54:57]
    v_mfma_f32_16x16x32_bf16 v[58:61], v[42:45], v[26:29], v[58:61]
    s_waitcnt lgkmcnt(2)
    v_mfma_f32_16x16x32_bf16 v[54:57], a[56:59], v[30:33], v[54:57]
    v_mfma_f32_16x16x32_bf16 v[58:61], v[46:49], v[30:33], v[58:61]
    s_waitcnt lgkmcnt(0)
    v_mfma_f32_16x16x32_bf16 v[54:57], a[60:63], v[34:37], v[54:57]
    v_mfma_f32_16x16x32_bf16 v[58:61], v[50:53], v[34:37], v[58:61]
    s_lshl_b32 s49, s3, 2
    s_add_u32 s49, s49, 147968
    v_lshlrev_b32 v22, 6, v1
    v_add_u32 v22, s49, v22
    s_nop 2
    v_max3_f32 v62, v54, v55, v56
    v_max3_f32 v21, v58, v59, v60
    v_max3_f32 v62, v62, v57, v61
    v_max_f32 v62, v62, v21
    s_nop 1
    v_max_f32_dpp v62, v62, v62 row_ror:4 row_mask:0xf bank_mask:0xf
    s_nop 1
    v_max_f32_dpp v62, v62, v62 row_ror:8 row_mask:0xf bank_mask:0xf
    v_mov_b32 v21, v62
    s_nop 1
    v_permlane32_swap_b32 v62, v21
    s_nop 0
    v_max_f32 v62, v62, v21
    v_mov_b32 v21, v62
    s_nop 1
    v_permlane16_swap_b32 v62, v21
    s_nop 0
    v_max_f32 v62, v62, v21
    v_mul_f32 v62, v17, v62
    v_pk_fma_f32 v[54:55], v[54:55], v[16:17], v[62:63] op_sel:[0,1,0] op_sel_hi:[1,1,0] neg_lo:[0,0,1] neg_hi:[0,0,1]
    v_pk_fma_f32 v[56:57], v[56:57], v[16:17], v[62:63] op_sel:[0,1,0] op_sel_hi:[1,1,0] neg_lo:[0,0,1] neg_hi:[0,0,1]
    v_pk_fma_f32 v[58:59], v[58:59], v[16:17], v[62:63] op_sel:[0,1,0] op_sel_hi:[1,1,0] neg_lo:[0,0,1] neg_hi:[0,0,1]
    v_pk_fma_f32 v[60:61], v[60:61], v[16:17], v[62:63] op_sel:[0,1,0] op_sel_hi:[1,1,0] neg_lo:[0,0,1] neg_hi:[0,0,1]
    s_mov_b64 exec, 15
    ds_write_b32 v22, v62
    s_mov_b64 exec, -1
    v_exp_f32 v54, v54
    v_exp_f32 v55, v55
    v_exp_f32 v56, v56
    v_exp_f32 v57, v57
    v_exp_f32 v58, v58
    v_exp_f32 v59, v59
    v_exp_f32 v60, v60
    v_exp_f32 v61, v61
    v_mov_b32 v62, v22
    v_cvt_pk_bf16_f32 v38, v54, v55
    v_cvt_pk_bf16_f32 v39, v56, v57
    v_cvt_pk_bf16_f32 v46, v58, v59
    v_cvt_pk_bf16_f32 v47, v60, v61
    s_cmp_lt_u32 s24, s13
    s_cbranch_scc1 L_a2lw0
L_a2lv0:
    s_waitcnt vmcnt(0)
    ds_read_b64_tr_b16 v[22:23], v11 offset:0
    ds_read_b64_tr_b16 v[24:25], v11 offset:4096
    ds_read_b64_tr_b16 v[26:27], v11 offset:8192
    ds_read_b64_tr_b16 v[28:29], v11 offset:12288
    v_xor_b32 v21, 32, v11
    ds_read_b64_tr_b16 v[30:31], v21 offset:0
    ds_read_b64_tr_b16 v[32:33], v21 offset:4096
    ds_read_b64_tr_b16 v[34:35], v21 offset:8192
    ds_read_b64_tr_b16 v[36:37], v21 offset:12288
    v_mov_b32_dpp v40, v38 row_shl:4 row_mask:0xf bank_mask:0xf
    v_mov_b32_dpp v41, v39 row_shl:4 row_mask:0xf bank_mask:0xf
    v_pk_add_f32 v[54:55], v[54:55], v[56:57]
    v_mov_b32_dpp v42, v38 row_shl:8 row_mask:0xf bank_mask:0xf
    v_mov_b32_dpp v43, v39 row_shl:8 row_mask:0xf bank_mask:0xf
    v_pk_add_f32 v[58:59], v[58:59], v[60:61]
    v_mov_b32_dpp v44, v38 row_shl:12 row_mask:0xf bank_mask:0xf
    v_mov_b32_dpp v45, v39 row_shl:12 row_mask:0xf bank_mask:0xf
    v_pk_add_f32 v[54:55], v[54:55], v[58:59]
    v_mov_b32_dpp v48, v46 row_shl:4 row_mask:0xf bank_mask:0xf
    v_mov_b32_dpp v49, v47 row_shl:4 row_mask:0xf bank_mask:0xf
    v_add_f32 v19, v54, v55
    v_mfma_f32_16x16x32_bf16 v[54:57], v[64:67], v[38:41], 0
    v_mov_b32_dpp v50, v46 row_shl:8 row_mask:0xf bank_mask:0xf
    v_mov_b32_dpp v51, v47 row_shl:8 row_mask:0xf bank_mask:0xf
    v_mfma_f32_16x16x32_bf16 v[54:57], v[96:99], v[42:45], v[54:57]
    v_mov_b32_dpp v52, v46 row_shl:12 row_mask:0xf bank_mask:0xf
    v_mov_b32_dpp v53, v47 row_shl:12 row_mask:0xf bank_mask:0xf
    s_waitcnt lgkmcnt(4)
    v_mfma_f32_16x16x32_bf16 v[54:57], v[22:25], v[46:49], v[54:57]
    v_xor_b32 v21, 64, v11
    v_mfma_f32_16x16x32_bf16 v[54:57], v[26:29], v[50:53], v[54:57]
    ds_read_b64_tr_b16 v[22:23], v21 offset:0
    ds_read_b64_tr_b16 v[24:25], v21 offset:4096
    ds_read_b64_tr_b16 v[26:27], v21 offset:8192
    ds_read_b64_tr_b16 v[28:29], v21 offset:12288
    v_mfma_f32_16x16x32_bf16 v[58:61], v[68:71], v[38:41], 0
    v_add_f32_dpp v19, v19, v19 row_ror:4 row_mask:0xf bank_mask:0xf
    v_mfma_f32_16x16x32_bf16 v[58:61], v[100:103], v[42:45], v[58:61]
    s_waitcnt lgkmcnt(4)
    v_mfma_f32_16x16x32_bf16 v[58:61], v[30:33], v[46:49], v[58:61]
    v_xor_b32 v21, 96, v11
    v_mfma_f32_16x16x32_bf16 v[58:61], v[34:37], v[50:53], v[58:61]
    s_mov_b64 exec, s[98:99]
    ds_write_b128 v13, v[54:57] offset:0
    s_mov_b64 exec, -1
    ds_read_b64_tr_b16 v[30:31], v21 offset:0
    ds_read_b64_tr_b16 v[32:33], v21 offset:4096
    ds_read_b64_tr_b16 v[34:35], v21 offset:8192
    ds_read_b64_tr_b16 v[36:37], v21 offset:12288
    v_mfma_f32_16x16x32_bf16 v[54:57], v[72:75], v[38:41], 0
    v_add_f32_dpp v19, v19, v19 row_ror:8 row_mask:0xf bank_mask:0xf
    v_mfma_f32_16x16x32_bf16 v[54:57], v[104:107], v[42:45], v[54:57]
    s_waitcnt lgkmcnt(5)
    v_mfma_f32_16x16x32_bf16 v[54:57], v[22:25], v[46:49], v[54:57]
    v_xor_b32 v21, 128, v11
    v_mfma_f32_16x16x32_bf16 v[54:57], v[26:29], v[50:53], v[54:57]
    s_mov_b64 exec, s[98:99]
    ds_write_b128 v13, v[58:61] offset:64
    s_mov_b64 exec, -1
    ds_read_b64_tr_b16 v[22:23], v21 offset:0
    ds_read_b64_tr_b16 v[24:25], v21 offset:4096
    ds_read_b64_tr_b16 v[26:27], v21 offset:8192
    ds_read_b64_tr_b16 v[28:29], v21 offset:12288
    v_mfma_f32_16x16x32_bf16 v[58:61], v[76:79], v[38:41], 0
    v_mov_b32 v17, v19
    v_mfma_f32_16x16x32_bf16 v[58:61], v[108:111], v[42:45], v[58:61]
    s_waitcnt lgkmcnt(5)
    v_mfma_f32_16x16x32_bf16 v[58:61], v[30:33], v[46:49], v[58:61]
    v_xor_b32 v21, 160, v11
    v_mfma_f32_16x16x32_bf16 v[58:61], v[34:37], v[50:53], v[58:61]
    s_mov_b64 exec, s[98:99]
    ds_write_b128 v13, v[54:57] offset:128
    s_mov_b64 exec, -1
    ds_read_b64_tr_b16 v[30:31], v21 offset:0
    ds_read_b64_tr_b16 v[32:33], v21 offset:4096
    ds_read_b64_tr_b16 v[34:35], v21 offset:8192
    ds_read_b64_tr_b16 v[36:37], v21 offset:12288
    v_mfma_f32_16x16x32_bf16 v[54:57], v[80:83], v[38:41], 0
    v_permlane32_swap_b32 v19, v17
    v_mfma_f32_16x16x32_bf16 v[54:57], v[112:115], v[42:45], v[54:57]
    v_add_f32 v19, v19, v17
    s_waitcnt lgkmcnt(5)
    v_mfma_f32_16x16x32_bf16 v[54:57], v[22:25], v[46:49], v[54:57]
    v_xor_b32 v21, 192, v11
    v_mfma_f32_16x16x32_bf16 v[54:57], v[26:29], v[50:53], v[54:57]
    s_mov_b64 exec, s[98:99]
    ds_write_b128 v13, v[58:61] offset:192
    s_mov_b64 exec, -1
    ds_read_b64_tr_b16 v[22:23], v21 offset:0
    ds_read_b64_tr_b16 v[24:25], v21 offset:4096
    ds_read_b64_tr_b16 v[26:27], v21 offset:8192
    ds_read_b64_tr_b16 v[28:29], v21 offset:12288
    v_mfma_f32_16x16x32_bf16 v[58:61], v[84:87], v[38:41], 0
    v_mov_b32 v17, v19
    v_mfma_f32_16x16x32_bf16 v[58:61], v[116:119], v[42:45], v[58:61]
    s_waitcnt lgkmcnt(5)
    v_mfma_f32_16x16x32_bf16 v[58:61], v[30:33], v[46:49], v[58:61]
    v_xor_b32 v21, 224, v11
    v_mfma_f32_16x16x32_bf16 v[58:61], v[34:37], v[50:53], v[58:61]
    s_mov_b64 exec, s[98:99]
    ds_write_b128 v13, v[54:57] offset:256
    s_mov_b64 exec, -1
    ds_read_b64_tr_b16 v[30:31], v21 offset:0
    ds_read_b64_tr_b16 v[32:33], v21 offset:4096
    ds_read_b64_tr_b16 v[34:35], v21 offset:8192
    ds_read_b64_tr_b16 v[36:37], v21 offset:12288
    v_mfma_f32_16x16x32_bf16 v[54:57], v[88:91], v[38:41], 0
    v_permlane16_swap_b32 v19, v17
    v_mfma_f32_16x16x32_bf16 v[54:57], v[120:123], v[42:45], v[54:57]
    v_add_f32 v19, v19, v17
    s_waitcnt lgkmcnt(5)
    v_mfma_f32_16x16x32_bf16 v[54:57], v[22:25], v[46:49], v[54:57]
    v_mfma_f32_16x16x32_bf16 v[54:57], v[26:29], v[50:53], v[54:57]
    s_mov_b64 exec, s[98:99]
    ds_write_b128 v13, v[58:61] offset:320
    s_mov_b64 exec, -1
    s_nop 3
    v_mfma_f32_16x16x32_bf16 v[58:61], v[92:95], v[38:41], 0
    s_mov_b64 exec, 15
    ds_write_b32 v62, v19 offset:32
    s_mov_b64 exec, -1
    v_mfma_f32_16x16x32_bf16 v[58:61], v[124:127], v[42:45], v[58:61]
    s_waitcnt lgkmcnt(2)
    v_mfma_f32_16x16x32_bf16 v[58:61], v[30:33], v[46:49], v[58:61]
    v_mfma_f32_16x16x32_bf16 v[58:61], v[34:37], v[50:53], v[58:61]
    s_mov_b64 exec, s[98:99]
    ds_write_b128 v13, v[54:57] offset:384
    s_mov_b64 exec, -1
    s_lshl_b32 s48, s3, 6
    s_add_u32 s48, s48, 147968
    s_mov_b64 exec, s[98:99]
    s_nop 2
    ds_write_b128 v13, v[58:61] offset:448
    s_mov_b64 exec, -1
    s_nop 1
    v_mov_b32 v54, s48
    v_mov_b32 v55, v14
    s_branch L_a2Sb
L_a2l2:
    ds_read_b128 v[22:25], v0
    ds_read_b128 v[38:41], v10
    ds_read_b128 v[26:29], v0 offset:64
    v_xor_b32 v21, 64, v10
    ds_read_b128 v[42:45], v21
    ds_read_b128 v[30:33], v0 offset:128
    v_xor_b32 v21, 128, v10
    ds_read_b128 v[46:49], v21
    ds_read_b128 v[34:37], v0 offset:192
    v_xor_b32 v21, 192, v10
    ds_read_b128 v[50:53], v21
    v_mov_b32_dpp v62, v0 row_ror:4 row_mask:0xf bank_mask:0xf
    s_waitcnt lgkmcnt(6)
    v_mfma_f32_16x16x32_bf16 v[54:57], a[128:131], v[22:25], 0
    v_mfma_f32_16x16x32_bf16 v[58:61], v[38:41], v[22:25], 0
    ds_read_b128 v[22:25], v62 offset:0
    ds_read_b128 v[38:41], v10 offset:4096
    s_waitcnt lgkmcnt(6)
    v_mfma_f32_16x16x32_bf16 v[54:57], a[132:135], v[26:29], v[54:57]
    v_xor_b32 v21, 64, v10
    v_mfma_f32_16x16x32_bf16 v[58:61], v[42:45], v[26:29], v[58:61]
    ds_read_b128 v[26:29], v62 offset:64
    ds_read_b128 v[42:45], v21 offset:4096
    s_waitcnt lgkmcnt(6)
    v_mfma_f32_16x16x32_bf16 v[54:57], a[136:139], v[30:33], v[54:57]
    v_xor_b32 v21, 128, v10
    v_mfma_f32_16x16x32_bf16 v[58:61], v[46:49], v[30:33], v[58:61]
    ds_read_b128 v[30:33], v62 offset:128
    ds_read_b128 v[46:49], v21 offset:4096
    s_waitcnt lgkmcnt(6)
    v_mfma_f32_16x16x32_bf16 v[54:57], a[140:143], v[34:37], v[54:57]
    v_xor_b32 v21, 192, v10
    v_mfma_f32_16x16x32_bf16 v[58:61], v[50:53], v[34:37], v[58:61]
    ds_read_b128 v[34:37], v62 offset:192
    ds_read_b128 v[50:53], v21 offset:4096
    v_mov_b32_dpp v62, v0 row_ror:8 row_mask:0xf bank_mask:0xf
    s_waitcnt lgkmcnt(6)
    v_mfma_f32_16x16x32_bf16 v[54:57], a[144:147], v[22:25], v[54:57]
    v_mfma_f32_16x16x32_bf16 v[58:61], v[38:41], v[22:25], v[58:61]
    ds_read_b128 v[22:25], v62 offset:0
    ds_read_b128 v[38:41], v10 offset:8192
    s_waitcnt lgkmcnt(6)
    v_mfma_f32_16x16x32_bf16 v[54:57], a[148:151], v[26:29], v[54:57]
    v_xor_b32 v21, 64, v10
    v_mfma_f32_16x16x32_bf16 v[58:61], v[42:45], v[26:29], v[58:61]
    ds_read_b128 v[26:29], v62 offset:64
    ds_read_b128 v[42:45], v21 offset:8192
    s_waitcnt lgkmcnt(6)
    v_mfma_f32_16x16x32_bf16 v[54:57], a[152:155], v[30:33], v[54:57]
    v_xor_b32 v21, 128, v10
    v_mfma_f32_16x16x32_bf16 v[58:61], v[46:49], v[30:33], v[58:61]
    ds_read_b128 v[30:33], v62 offset:128
    ds_read_b128 v[46:49], v21 offset:8192
    s_waitcnt lgkmcnt(6)
    v_mfma_f32_16x16x32_bf16 v[54:57], a[156:159], v[34:37], v[54:57]
    v_xor_b32 v21, 192, v10
    v_mfma_f32_16x16x32_bf16 v[58:61], v[50:53], v[34:37], v[58:61]
    ds_read_b128 v[34:37], v62 offset:192
    ds_read_b128 v[50:53], v21 offset:8192
    v_mov_b32_dpp v62, v0 row_ror:12 row_mask:0xf bank_mask:0xf
    s_waitcnt lgkmcnt(6)
    v_mfma_f32_16x16x32_bf16 v[54:57], a[160:163], v[22:25], v[54:57]
    v_mfma_f32_16x16x32_bf16 v[58:61], v[38:41], v[22:25], v[58:61]
    ds_read_b128 v[22:25], v62 offset:0
    ds_read_b128 v[38:41], v10 offset:12288
    s_waitcnt lgkmcnt(6)
    v_mfma_f32_16x16x32_bf16 v[54:57], a[164:167], v[26:29], v[54:57]
    v_xor_b32 v21, 64, v10
    v_mfma_f32_16x16x32_bf16 v[58:61], v[42:45], v[26:29], v[58:61]
    ds_read_b128 v[26:29], v62 offset:64
    ds_read_b128 v[42:45], v21 offset:12288
    s_waitcnt lgkmcnt(6)
    v_mfma_f32_16x16x32_bf16 v[54:57], a[168:171], v[30:33], v[54:57]
    v_xor_b32 v21, 128, v10
    v_mfma_f32_16x16x32_bf16 v[58:61], v[46:49], v[30:33], v[58:61]
    ds_read_b128 v[30:33], v62 offset:128
    ds_read_b128 v[46:49], v21 offset:12288
    s_waitcnt lgkmcnt(6)
    v_mfma_f32_16x16x32_bf16 v[54:57], a[172:175], v[34:37], v[54:57]
    v_xor_b32 v21, 192, v10
    v_mfma_f32_16x16x32_bf16 v[58:61], v[50:53], v[34:37], v[58:61]
    ds_read_b128 v[34:37], v62 offset:192
    ds_read_b128 v[50:53], v21 offset:12288
    s_waitcnt lgkmcnt(6)
    v_mfma_f32_16x16x32_bf16 v[54:57], a[176:179], v[22:25], v[54:57]
    v_mfma_f32_16x16x32_bf16 v[58:61], v[38:41], v[22:25], v[58:61]
    s_waitcnt lgkmcnt(4)
    v_mfma_f32_16x16x32_bf16 v[54:57], a[180:183], v[26:29], v[54:57]
    v_mfma_f32_16x16x32_bf16 v[58:61], v[42:45], v[26:29], v[58:61]
    s_waitcnt lgkmcnt(2)
    v_mfma_f32_16x16x32_bf16 v[54:57], a[184:187], v[30:33], v[54:57]
    v_mfma_f32_16x16x32_bf16 v[58:61], v[46:49], v[30:33], v[58:61]
    s_waitcnt lgkmcnt(0)
    v_mfma_f32_16x16x32_bf16 v[54:57], a[188:191], v[34:37], v[54:57]
    v_mfma_f32_16x16x32_bf16 v[58:61], v[50:53], v[34:37], v[58:61]
    s_lshl_b32 s49, s3, 2
    s_add_u32 s49, s49, 147968
    v_lshlrev_b32 v22, 6, v1
    v_add_u32 v22, s49, v22
    s_nop 2
    v_max3_f32 v62, v54, v55, v56
    v_max3_f32 v21, v58, v59, v60
    v_max3_f32 v62, v62, v57, v61
    v_max_f32 v62, v62, v21
    s_nop 1
    v_max_f32_dpp v62, v62, v62 row_ror:4 row_mask:0xf bank_mask:0xf
    s_nop 1
    v_max_f32_dpp v62, v62, v62 row_ror:8 row_mask:0xf bank_mask:0xf
    v_mov_b32 v21, v62
    s_nop 1
    v_permlane32_swap_b32 v62, v21
    s_nop 0
    v_max_f32 v62, v62, v21
    v_mov_b32 v21, v62
    s_nop 1
    v_permlane16_swap_b32 v62, v21
    s_nop 0
    v_max_f32 v62, v62, v21
    v_mul_f32 v62, v17, v62
    v_pk_fma_f32 v[54:55], v[54:55], v[16:17], v[62:63] op_sel:[0,1,0] op_sel_hi:[1,1,0] neg_lo:[0,0,1] neg_hi:[0,0,1]
    v_pk_fma_f32 v[56:57], v[56:57], v[16:17], v[62:63] op_sel:[0,1,0] op_sel_hi:[1,1,0] neg_lo:[0,0,1] neg_hi:[0,0,1]
    v_pk_fma_f32 v[58:59], v[58:59], v[16:17], v[62:63] op_sel:[0,1,0] op_sel_hi:[1,1,0] neg_lo:[0,0,1] neg_hi:[0,0,1]
    v_pk_fma_f32 v[60:61], v[60:61], v[16:17], v[62:63] op_sel:[0,1,0] op_sel_hi:[1,1,0] neg_lo:[0,0,1] neg_hi:[0,0,1]
    s_mov_b64 exec, 15
    ds_write_b32 v22, v62
    s_mov_b64 exec, -1
    v_exp_f32 v54, v54
    v_exp_f32 v55, v55
    v_exp_f32 v56, v56
    v_exp_f32 v57, v57
    v_exp_f32 v58, v58
    v_exp_f32 v59, v59
    v_exp_f32 v60, v60
    v_exp_f32 v61, v61
    v_mov_b32 v62, v22
    v_cvt_pk_bf16_f32 v38, v54, v55
    v_cvt_pk_bf16_f32 v39, v56, v57
    v_cvt_pk_bf16_f32 v46, v58, v59
    v_cvt_pk_bf16_f32 v47, v60, v61
    s_cmp_lt_u32 s24, s13
    s_cbranch_scc1 L_a2lw2
L_a2lv2:
    s_waitcnt vmcnt(0)
    ds_read_b64_tr_b16 v[22:23], v11 offset:0
    ds_read_b64_tr_b16 v[24:25], v11 offset:4096
    ds_read_b64_tr_b16 v[26:27], v11 offset:8192
    ds_read_b64_tr_b16 v[28:29], v11 offset:12288
    v_xor_b32 v21, 32, v11
    ds_read_b64_tr_b16 v[30:31], v21 offset:0
    ds_read_b64_tr_b16 v[32:33], v21 offset:4096
    ds_read_b64_tr_b16 v[34:35], v21 offset:8192
    ds_read_b64_tr_b16 v[36:37], v21 offset:12288
    v_mov_b32_dpp v40, v38 row_shl:4 row_mask:0xf bank_mask:0xf
    v_mov_b32_dpp v41, v39 row_shl:4 row_mask:0xf bank_mask:0xf
    v_pk_add_f32 v[54:55], v[54:55], v[56:57]
    v_mov_b32_dpp v42, v38 row_shl:8 row_mask:0xf bank_mask:0xf
    v_mov_b32_dpp v43, v39 row_shl:8 row_mask:0xf bank_mask:0xf
    v_pk_add_f32 v[58:59], v[58:59], v[60:61]
    v_mov_b32_dpp v44, v38 row_shl:12 row_mask:0xf bank_mask:0xf
    v_mov_b32_dpp v45, v39 row_shl:12 row_mask:0xf bank_mask:0xf
    v_pk_add_f32 v[54:55], v[54:55], v[58:59]
    v_mov_b32_dpp v48, v46 row_shl:4 row_mask:0xf bank_mask:0xf
    v_mov_b32_dpp v49, v47 row_shl:4 row_mask:0xf bank_mask:0xf
    v_add_f32 v19, v54, v55
    v_mfma_f32_16x16x32_bf16 v[54:57], v[192:195], v[38:41], 0
    v_mov_b32_dpp v50, v46 row_shl:8 row_mask:0xf bank_mask:0xf
    v_mov_b32_dpp v51, v47 row_shl:8 row_mask:0xf bank_mask:0xf
    v_mfma_f32_16x16x32_bf16 v[54:57], v[224:227], v[42:45], v[54:57]
    v_mov_b32_dpp v52, v46 row_shl:12 row_mask:0xf bank_mask:0xf
    v_mov_b32_dpp v53, v47 row_shl:12 row_mask:0xf bank_mask:0xf
    s_waitcnt lgkmcnt(4)
    v_mfma_f32_16x16x32_bf16 v[54:57], v[22:25], v[46:49], v[54:57]
    v_xor_b32 v21, 64, v11
    v_mfma_f32_16x16x32_bf16 v[54:57], v[26:29], v[50:53], v[54:57]
    ds_read_b64_tr_b16 v[22:23], v21 offset:0
    ds_read_b64_tr_b16 v[24:25], v21 offset:4096
    ds_read_b64_tr_b16 v[26:27], v21 offset:8192
    ds_read_b64_tr_b16 v[28:29], v21 offset:12288
    v_mfma_f32_16x16x32_bf16 v[58:61], v[196:199], v[38:41], 0
    v_add_f32_dpp v19, v19, v19 row_ror:4 row_mask:0xf bank_mask:0xf
    v_mfma_f32_16x16x32_bf16 v[58:61], v[228:231], v[42:45], v[58:61]
    s_waitcnt lgkmcnt(4)
    v_mfma_f32_16x16x32_bf16 v[58:61], v[30:33], v[46:49], v[58:61]
    v_xor_b32 v21, 96, v11
    v_mfma_f32_16x16x32_bf16 v[58:61], v[34:37], v[50:53], v[58:61]
    s_mov_b64 exec, s[98:99]
    ds_write_b128 v13, v[54:57] offset:0
    s_mov_b64 exec, -1
    ds_read_b64_tr_b16 v[30:31], v21 offset:0
    ds_read_b64_tr_b16 v[32:33], v21 offset:4096
    ds_read_b64_tr_b16 v[34:35], v21 offset:8192
    ds_read_b64_tr_b16 v[36:37], v21 offset:12288
    v_mfma_f32_16x16x32_bf16 v[54:57], v[200:203], v[38:41], 0
    v_add_f32_dpp v19, v19, v19 row_ror:8 row_mask:0xf bank_mask:0xf
    v_mfma_f32_16x16x32_bf16 v[54:57], v[232:235], v[42:45], v[54:57]
    s_waitcnt lgkmcnt(5)
    v_mfma_f32_16x16x32_bf16 v[54:57], v[22:25], v[46:49], v[54:57]
    v_xor_b32 v21, 128, v11
    v_mfma_f32_16x16x32_bf16 v[54:57], v[26:29], v[50:53], v[54:57]
    s_mov_b64 exec, s[98:99]
    ds_write_b128 v13, v[58:61] offset:64
    s_mov_b64 exec, -1
    ds_read_b64_tr_b16 v[22:23], v21 offset:0
    ds_read_b64_tr_b16 v[24:25], v21 offset:4096
    ds_read_b64_tr_b16 v[26:27], v21 offset:8192
    ds_read_b64_tr_b16 v[28:29], v21 offset:12288
    v_mfma_f32_16x16x32_bf16 v[58:61], v[204:207], v[38:41], 0
    v_mov_b32 v17, v19
    v_mfma_f32_16x16x32_bf16 v[58:61], v[236:239], v[42:45], v[58:61]
    s_waitcnt lgkmcnt(5)
    v_mfma_f32_16x16x32_bf16 v[58:61], v[30:33], v[46:49], v[58:61]
    v_xor_b32 v21, 160, v11
    v_mfma_f32_16x16x32_bf16 v[58:61], v[34:37], v[50:53], v[58:61]
    s_mov_b64 exec, s[98:99]
    ds_write_b128 v13, v[54:57] offset:128
    s_mov_b64 exec, -1
    ds_read_b64_tr_b16 v[30:31], v21 offset:0
    ds_read_b64_tr_b16 v[32:33], v21 offset:4096
    ds_read_b64_tr_b16 v[34:35], v21 offset:8192
    ds_read_b64_tr_b16 v[36:37], v21 offset:12288
    v_mfma_f32_16x16x32_bf16 v[54:57], v[208:211], v[38:41], 0
    v_permlane32_swap_b32 v19, v17
    v_mfma_f32_16x16x32_bf16 v[54:57], v[240:243], v[42:45], v[54:57]
    v_add_f32 v19, v19, v17
    s_waitcnt lgkmcnt(5)
    v_mfma_f32_16x16x32_bf16 v[54:57], v[22:25], v[46:49], v[54:57]
    v_xor_b32 v21, 192, v11
    v_mfma_f32_16x16x32_bf16 v[54:57], v[26:29], v[50:53], v[54:57]
    s_mov_b64 exec, s[98:99]
    ds_write_b128 v13, v[58:61] offset:192
    s_mov_b64 exec, -1
    ds_read_b64_tr_b16 v[22:23], v21 offset:0
    ds_read_b64_tr_b16 v[24:25], v21 offset:4096
    ds_read_b64_tr_b16 v[26:27], v21 offset:8192
    ds_read_b64_tr_b16 v[28:29], v21 offset:12288
    v_mfma_f32_16x16x32_bf16 v[58:61], v[212:215], v[38:41], 0
    v_mov_b32 v17, v19
    v_mfma_f32_16x16x32_bf16 v[58:61], v[244:247], v[42:45], v[58:61]
    s_waitcnt lgkmcnt(5)
    v_mfma_f32_16x16x32_bf16 v[58:61], v[30:33], v[46:49], v[58:61]
    v_xor_b32 v21, 224, v11
    v_mfma_f32_16x16x32_bf16 v[58:61], v[34:37], v[50:53], v[58:61]
    s_mov_b64 exec, s[98:99]
    ds_write_b128 v13, v[54:57] offset:256
    s_mov_b64 exec, -1
    ds_read_b64_tr_b16 v[30:31], v21 offset:0
    ds_read_b64_tr_b16 v[32:33], v21 offset:4096
    ds_read_b64_tr_b16 v[34:35], v21 offset:8192
    ds_read_b64_tr_b16 v[36:37], v21 offset:12288
    v_mfma_f32_16x16x32_bf16 v[54:57], v[216:219], v[38:41], 0
    v_permlane16_swap_b32 v19, v17
    v_mfma_f32_16x16x32_bf16 v[54:57], v[248:251], v[42:45], v[54:57]
    v_add_f32 v19, v19, v17
    s_waitcnt lgkmcnt(5)
    v_mfma_f32_16x16x32_bf16 v[54:57], v[22:25], v[46:49], v[54:57]
    v_mfma_f32_16x16x32_bf16 v[54:57], v[26:29], v[50:53], v[54:57]
    s_mov_b64 exec, s[98:99]
    ds_write_b128 v13, v[58:61] offset:320
    s_mov_b64 exec, -1
    s_nop 3
    v_mfma_f32_16x16x32_bf16 v[58:61], v[220:223], v[38:41], 0
    s_mov_b64 exec, 15
    ds_write_b32 v62, v19 offset:32
    s_mov_b64 exec, -1
    v_mfma_f32_16x16x32_bf16 v[58:61], v[252:255], v[42:45], v[58:61]
    s_waitcnt lgkmcnt(2)
    v_mfma_f32_16x16x32_bf16 v[58:61], v[30:33], v[46:49], v[58:61]
    v_mfma_f32_16x16x32_bf16 v[58:61], v[34:37], v[50:53], v[58:61]
    s_mov_b64 exec, s[98:99]
    ds_write_b128 v13, v[54:57] offset:384
    s_mov_b64 exec, -1
    s_lshl_b32 s48, s3, 6
    s_add_u32 s48, s48, 147968
    s_mov_b64 exec, s[98:99]
    s_nop 2
    ds_write_b128 v13, v[58:61] offset:448
    s_mov_b64 exec, -1
    s_nop 1
    v_mov_b32 v54, s48
    v_mov_b32 v55, v14
    s_branch L_a2Sb
L_a2lx:
    s_add_u32 s31, s31, 1
    s_cmp_gt_u32 s31, 1000000
    s_cbranch_scc1 L_done
    s_cmp_ge_u32 s24, s25
    s_cbranch_scc1 Lpk_101
    s_getreg_b32 s0, hwreg(HW_REG_IB_STS)
    s_and_b32 s0, s0, 0xc0000f
    s_cmp_gt_u32 s0, s54
    s_cbranch_scc1 Lpk_101
    s_mov_b32 m0, s26
    s_add_u32 s0, s16, s101
    s_addc_u32 s1, s17, 0
    s_add_u32 s24, s24, 2
    global_load_lds_dwordx4 v8, s[0:1] nt
    global_load_lds_dwordx4 v9, s[0:1] offset:1024 nt
    s_add_u32 s101, s101, 65536
    s_and_b32 s101, s101, 0x7ffff
    s_add_u32 s26, s26, 2048
    s_and_b32 s0, s24, 15
    s_cbranch_scc0 Lps_102
Lpk_101:
    s_cmp_ge_u32 s24, s25
    s_cbranch_scc1 Lpk_103
    s_getreg_b32 s0, hwreg(HW_REG_IB_STS)
    s_and_b32 s0, s0, 0xc0000f
    s_cmp_gt_u32 s0, s54
    s_cbranch_scc1 Lpk_103
    s_mov_b32 m0, s26
    s_add_u32 s0, s16, s101
    s_addc_u32 s1, s17, 0
    s_add_u32 s24, s24, 2
    global_load_lds_dwordx4 v8, s[0:1] nt
    global_load_lds_dwordx4 v9, s[0:1] offset:1024 nt
    s_add_u32 s101, s101, 65536
    s_and_b32 s101, s101, 0x7ffff
    s_add_u32 s26, s26, 2048
    s_and_b32 s0, s24, 15
    s_cbranch_scc0 Lps_104
Lpk_103:
    s_call_b64 s[62:63], L_service
    s_branch L_a2l
L_a2ly:
    s_add_u32 s31, s31, 1
    s_cmp_gt_u32 s31, 1000000
    s_cbranch_scc1 L_done
    s_call_b64 s[62:63], L_service
    s_mov_b32 s100, s29
    s_cmp_ge_u32 s24, s25
    s_cbranch_scc1 Lpk_105
    s_getreg_b32 s0, hwreg(HW_REG_IB_STS)
    s_and_b32 s0, s0, 0xc0000f
    s_cmp_gt_u32 s0, s54
    s_cbranch_scc1 Lpk_105
    s_mov_b32 m0, s26
    s_add_u32 s0, s16, s101
    s_addc_u32 s1, s17, 0
    s_add_u32 s24, s24, 2
    global_load_lds_dwordx4 v8, s[0:1] nt
    global_load_lds_dwordx4 v9, s[0:1] offset:1024 nt
    s_add_u32 s101, s101, 65536
    s_and_b32 s101, s101, 0x7ffff
    s_add_u32 s26, s26, 2048
    s_and_b32 s0, s24, 15
    s_cbranch_scc0 Lps_106
Lpk_105:
    s_cmp_ge_u32 s24, s25
    s_cbranch_scc1 Lpk_107
    s_getreg_b32 s0, hwreg(HW_REG_IB_STS)
    s_and_b32 s0, s0, 0xc0000f
    s_cmp_gt_u32 s0, s54
    s_cbranch_scc1 Lpk_107
    s_mov_b32 m0, s26
    s_add_u32 s0, s16, s101
    s_addc_u32 s1, s17, 0
    s_add_u32 s24, s24, 2
    global_load_lds_dwordx4 v8, s[0:1] nt
    global_load_lds_dwordx4 v9, s[0:1] offset:1024 nt
    s_add_u32 s101, s101, 65536
    s_and_b32 s101, s101, 0x7ffff
    s_add_u32 s26, s26, 2048
    s_and_b32 s0, s24, 15
    s_cbranch_scc0 Lps_108
Lpk_107:
    s_branch L_a2l
L_a2lw0:
    s_cmp_ge_u32 s24, s25
    s_cbranch_scc1 Lpk_93
    s_getreg_b32 s0, hwreg(HW_REG_IB_STS)
    s_and_b32 s0, s0, 0xc0000f
    s_cmp_gt_u32 s0, 12
    s_cbranch_scc1 Lpk_93
    s_mov_b32 m0, s26
    s_add_u32 s0, s16, s101
    s_addc_u32 s1, s17, 0
    s_add_u32 s24, s24, 2
    global_load_lds_dwordx4 v8, s[0:1] nt
    global_load_lds_dwordx4 v9, s[0:1] offset:1024 nt
    s_add_u32 s101, s101, 65536
    s_and_b32 s101, s101, 0x7ffff
    s_add_u32 s26, s26, 2048
    s_and_b32 s0, s24, 15
    s_cbranch_scc0 Lps_94
Lpk_93:
    s_cmp_ge_u32 s24, s25
    s_cbranch_scc1 Lpk_95
    s_getreg_b32 s0, hwreg(HW_REG_IB_STS)
    s_and_b32 s0, s0, 0xc0000f
    s_cmp_gt_u32 s0, 12
    s_cbranch_scc1 Lpk_95
    s_mov_b32 m0, s26
    s_add_u32 s0, s16, s101
    s_addc_u32 s1, s17, 0
    s_add_u32 s24, s24, 2
    global_load_lds_dwordx4 v8, s[0:1] nt
    global_load_lds_dwordx4 v9, s[0:1] offset:1024 nt
    s_add_u32 s101, s101, 65536
    s_and_b32 s101, s101, 0x7ffff
    s_add_u32 s26, s26, 2048
    s_and_b32 s0, s24, 15
    s_cbranch_scc0 Lps_96
Lpk_95:
    s_cmp_lt_u32 s24, s13
    s_cbranch_scc1 L_a2lw0
    s_branch L_a2lv0
Lps_94:
    s_call_b64 s[58:59], L_seg
    s_branch Lpk_93
Lps_96:
    s_call_b64 s[58:59], L_seg
    s_branch Lpk_95
L_a2lw2:
    s_cmp_ge_u32 s24, s25
    s_cbranch_scc1 Lpk_97
    s_getreg_b32 s0, hwreg(HW_REG_IB_STS)
    s_and_b32 s0, s0, 0xc0000f
    s_cmp_gt_u32 s0, 12
    s_cbranch_scc1 Lpk_97
    s_mov_b32 m0, s26
    s_add_u32 s0, s16, s101
    s_addc_u32 s1, s17, 0
    s_add_u32 s24, s24, 2
    global_load_lds_dwordx4 v8, s[0:1] nt
    global_load_lds_dwordx4 v9, s[0:1] offset:1024 nt
    s_add_u32 s101, s101, 65536
    s_and_b32 s101, s101, 0x7ffff
    s_add_u32 s26, s26, 2048
    s_and_b32 s0, s24, 15
    s_cbranch_scc0 Lps_98
Lpk_97:
    s_cmp_ge_u32 s24, s25
    s_cbranch_scc1 Lpk_99
    s_getreg_b32 s0, hwreg(HW_REG_IB_STS)
    s_and_b32 s0, s0, 0xc0000f
    s_cmp_gt_u32 s0, 12
    s_cbranch_scc1 Lpk_99
    s_mov_b32 m0, s26
    s_add_u32 s0, s16, s101
    s_addc_u32 s1, s17, 0
    s_add_u32 s24, s24, 2
    global_load_lds_dwordx4 v8, s[0:1] nt
    global_load_lds_dwordx4 v9, s[0:1] offset:1024 nt
    s_add_u32 s101, s101, 65536
    s_and_b32 s101, s101, 0x7ffff
    s_add_u32 s26, s26, 2048
    s_and_b32 s0, s24, 15
    s_cbranch_scc0 Lps_100
Lpk_99:
    s_cmp_lt_u32 s24, s13
    s_cbranch_scc1 L_a2lw2
    s_branch L_a2lv2
Lps_98:
    s_call_b64 s[58:59], L_seg
    s_branch Lpk_97
Lps_100:
    s_call_b64 s[58:59], L_seg
    s_branch Lpk_99
Lps_102:
    s_call_b64 s[58:59], L_seg
    s_branch Lpk_101
Lps_104:
    s_call_b64 s[58:59], L_seg
    s_branch Lpk_103
Lps_106:
    s_call_b64 s[58:59], L_seg
    s_branch Lpk_105
Lps_108:
    s_call_b64 s[58:59], L_seg
    s_branch Lpk_107
L_seq1:
    s_and_b32 s39, s39, 1
    s_branch L_a2l
L_seq:
    s_cmp_eq_u32 s91, 1
    s_mov_b32 s91, 0
    s_cbranch_scc1 L_nq1
    s_call_b64 s[60:61], L_att
    s_cmp_lg_u32 s28, 0
    s_cbranch_scc1 L_nq1
    s_mov_b32 s43, 0
    s_mov_b32 s50, 149568
    s_mov_b32 s94, 0
    s_mov_b32 s39, 8
    v_mov_b32 v18, v17
    s_add_u32 s14, s6, 10485760
    s_addc_u32 s15, s7, 0
    s_mov_b32 s88, 1
    s_call_b64 s[92:93], L_stq
    v_swap_b32 v17, v18
    s_mov_b32 s39, 0
    s_mov_b32 s94, 1
L_nq1:
    s_add_u32 s27, s27, 1
    s_call_b64 s[60:61], L_att
    s_cmp_eq_u32 s28, 4
    s_cselect_b32 s49, 1344, 0
    v_subrev_u32 v0, s49, v0
    s_lshl_b32 s48, s3, 6
    s_add_u32 s48, s48, 147968
    v_mov_b32 v54, s48
    v_lshrrev_b32 v55, 5, v1
    v_lshl_add_u32 v56, v55, 4, v54
    v_mul_u32_u24 v55, 4224, v55
    v_add_u32 v55, v55, v14
    v_mov_b32 v57, s89
    s_waitcnt lgkmcnt(0)
    s_barrier
    ds_read_b128 v[38:41], v54
    ds_read_b128 v[50:53], v54 offset:16
    ds_read_b128 v[58:61], v56
    ds_read_b128 v[46:49], v56 offset:32
    ds_read_b128 v[22:25], v55
    ds_read_b128 v[26:29], v55 offset:2112
    ds_read_b128 v[30:33], v55 offset:4224
    ds_read_b128 v[34:37], v55 offset:6336
    s_waitcnt lgkmcnt(6)
    v_max3_f32 v42, v38, v39, v40
    v_max3_f32 v43, v41, v50, v51
    v_max3_f32 v42, v42, v52, v53
    v_max_f32 v42, v42, v43
    s_waitcnt lgkmcnt(5)
    v_pk_add_f32 v[38:39], v[58:59], v[42:43] op_sel_hi:[1,0] neg_lo:[0,1] neg_hi:[0,1]
    v_pk_add_f32 v[40:41], v[60:61], v[42:43] op_sel_hi:[1,0] neg_lo:[0,1] neg_hi:[0,1]
    v_exp_f32 v38, v38
    v_exp_f32 v39, v39
    v_exp_f32 v40, v40
    v_exp_f32 v41, v41
    s_waitcnt lgkmcnt(3)
    v_pk_mul_f32 v[46:47], v[46:47], v[38:39]
    v_pk_fma_f32 v[46:47], v[48:49], v[40:41], v[46:47]
    v_pk_mul_f32 v[22:23], v[22:23], v[38:39] op_sel_hi:[1,0]
    v_pk_mul_f32 v[24:25], v[24:25], v[38:39] op_sel_hi:[1,0]
    v_add_f32 v43, v46, v47
    s_waitcnt lgkmcnt(2)
    v_pk_fma_f32 v[22:23], v[26:27], v[38:39], v[22:23] op_sel:[0,1,0] op_sel_hi:[1,1,1]
    v_pk_fma_f32 v[24:25], v[28:29], v[38:39], v[24:25] op_sel:[0,1,0] op_sel_hi:[1,1,1]
    v_mov_b32 v44, v43
    s_waitcnt lgkmcnt(1)
    v_pk_fma_f32 v[22:23], v[30:31], v[40:41], v[22:23] op_sel_hi:[1,0,1]
    v_pk_fma_f32 v[24:25], v[32:33], v[40:41], v[24:25] op_sel_hi:[1,0,1]
    v_permlane32_swap_b32 v43, v44
    s_waitcnt lgkmcnt(0)
    v_pk_fma_f32 v[22:23], v[34:35], v[40:41], v[22:23] op_sel:[0,1,0] op_sel_hi:[1,1,1]
    v_pk_fma_f32 v[24:25], v[36:37], v[40:41], v[24:25] op_sel:[0,1,0] op_sel_hi:[1,1,1]
    v_add_f32 v43, v43, v44
    s_branch L_cjoin
L_p0a:
    s_add_u32 s44, s6, s40
    s_addc_u32 s45, s7, 0
L_go2:
    s_add_u32 s31, s31, 1
    s_cmp_gt_u32 s31, 1000000
    s_cbranch_scc1 L_done
    s_load_dword s48, s[44:45], 4 glc
    s_waitcnt lgkmcnt(0)
    s_cmp_eq_u32 s48, -1
    s_cbranch_scc1 L_go2
    s_branch L_p0a_back
Lsv_109:
    s_call_b64 s[62:63], L_service
    s_branch Lsw_110
Lds_114:
    s_call_b64 s[62:63], L_service
    s_branch Ldb_112
Ldl_111:
    s_cmp_eq_u32 s94, 0
    s_cbranch_scc1 Ldb_112
    s_cmp_eq_u32 s94, 1
    s_cselect_b32 s51, 8, 8
Ldp_113:
    s_cmp_ge_u32 s24, s25
    s_cbranch_scc1 Lpk_115
    s_getreg_b32 s0, hwreg(HW_REG_IB_STS)
    s_and_b32 s0, s0, 0xc0000f
    s_cmp_gt_u32 s0, s54
    s_cbranch_scc1 Lpk_115
    s_mov_b32 m0, s26
    s_add_u32 s0, s16, s101
    s_addc_u32 s1, s17, 0
    s_add_u32 s24, s24, 2
    global_load_lds_dwordx4 v8, s[0:1] nt
    global_load_lds_dwordx4 v9, s[0:1] offset:1024 nt
    s_add_u32 s101, s101, 65536
    s_and_b32 s101, s101, 0x7ffff
    s_add_u32 s26, s26, 2048
    s_and_b32 s0, s24, 15
    s_cbranch_scc0 Lps_116
Lpk_115:
    s_cmp_lt_u32 s24, s25
    s_cbranch_scc1 Ldp_113x
    s_call_b64 s[62:63], L_service
Ldp_113x:
    s_sub_u32 s51, s51, 1
    s_cbranch_scc0 Ldp_113
    s_branch Ldb_112
Lps_116:
    s_call_b64 s[58:59], L_seg
    s_branch Lpk_115
L_wo2:
    s_mov_b32 s82, 16
    s_mul_i32 s48, s3, 272
    s_add_u32 s48, s48, 150912
    v_add_u32 v62, s48, v4
    s_branch L_gA
Lgs_119:
    s_mov_b32 s41, s24
    s_min_u32 s51, s56, s82
    s_add_u32 s51, s51, 5
    s_min_u32 s51, s51, 13
Lgw_117:
    s_getreg_b32 s0, hwreg(HW_REG_IB_STS)
    s_and_b32 s0, s0, 0xc0000f
    s_sub_u32 s1, s24, s41
    s_cmp_le_u32 s0, s1
    s_cselect_b32 s100, s41, s100
    s_cbranch_scc1 Lgd_118
    s_cmp_ge_u32 s24, s25
    s_cbranch_scc1 Lgv_120
    s_cmp_gt_u32 s0, s51
    s_cbranch_scc1 Lgw_117
    s_mov_b32 m0, s26
    s_add_u32 s0, s16, s101
    s_addc_u32 s1, s17, 0
    s_add_u32 s24, s24, 2
    global_load_lds_dwordx4 v8, s[0:1] nt
    global_load_lds_dwordx4 v9, s[0:1] offset:1024 nt
    s_add_u32 s101, s101, 65536
    s_and_b32 s101, s101, 0x7ffff
    s_add_u32 s26, s26, 2048
    s_and_b32 s0, s24, 15
    s_cbranch_scc0 Lps_121
Lpb_122:
    s_branch Lgw_117
Lgv_120:
    s_call_b64 s[62:63], L_service
    s_branch Lgw_117
Lps_121:
    s_call_b64 s[58:59], L_seg
    s_branch Lpb_122
Ltg_123:
    v_bitop3_b32 v57, v22, v24, v26 bitop3:0x80
    v_bitop3_b32 v57, v57, v28, v30 bitop3:0x80
    v_max_f32_dpp v56, v56, v56 quad_perm:[2,3,0,1] row_mask:0xf bank_mask:0xf
    v_bitop3_b32 v57, v57, v32, v34 bitop3:0x80
    v_bitop3_b32 v57, v57, v36, v54 bitop3:0x80
    s_branch Ltb_124
Ltr_125:
    s_mov_b64 exec, vcc
    s_branch L_gA
L_woB:
    s_waitcnt lgkmcnt(3)
    v_mfma_f32_16x16x32_bf16 v[22:25], a[224:227], v[30:33], 0
    s_waitcnt lgkmcnt(2)
    v_mfma_f32_16x16x32_bf16 v[22:25], a[228:231], v[34:37], v[22:25]
    s_waitcnt lgkmcnt(1)
    v_mfma_f32_16x16x32_bf16 v[22:25], a[232:235], v[38:41], v[22:25]
    s_waitcnt lgkmcnt(0)
    v_mfma_f32_16x16x32_bf16 v[22:25], a[236:239], v[42:45], v[22:25]
    s_branch L_woD
Lsv_126:
    s_call_b64 s[62:63], L_service
    s_branch Lsw_127
L_x0:
    s_add_u32 s49, s3, s28
    s_lshl_b32 s49, s49, 7
    s_mul_i32 s48, s3, 144
    s_sub_u32 s49, s49, s48
    s_add_u32 s49, s49, 2304
    v_add_u32 v22, s49, v15
    ds_read_u16 v16, v22
    s_waitcnt lgkmcnt(0)
    v_lshlrev_b32 v16, 16, v16
    s_branch L_nox0
Lds_131:
    s_call_b64 s[62:63], L_service
    s_branch Ldb_129
Ldl_128:
    s_cmp_eq_u32 s94, 0
    s_cbranch_scc1 Ldb_129
    s_cmp_eq_u32 s94, 1
    s_cselect_b32 s51, 20, 20
Ldp_130:
    s_cmp_ge_u32 s24, s25
    s_cbranch_scc1 Lpk_132
    s_getreg_b32 s0, hwreg(HW_REG_IB_STS)
    s_and_b32 s0, s0, 0xc0000f
    s_cmp_gt_u32 s0, s54
    s_cbranch_scc1 Lpk_132
    s_mov_b32 m0, s26
    s_add_u32 s0, s16, s101
    s_addc_u32 s1, s17, 0
    s_add_u32 s24, s24, 2
    global_load_lds_dwordx4 v8, s[0:1] nt
    global_load_lds_dwordx4 v9, s[0:1] offset:1024 nt
    s_add_u32 s101, s101, 65536
    s_and_b32 s101, s101, 0x7ffff
    s_add_u32 s26, s26, 2048
    s_and_b32 s0, s24, 15
    s_cbranch_scc0 Lps_133
Lpk_132:
    s_cmp_lt_u32 s24, s25
    s_cbranch_scc1 Ldp_130x
    s_call_b64 s[62:63], L_service
Ldp_130x:
    s_sub_u32 s51, s51, 1
    s_cbranch_scc0 Ldp_130
    s_branch Ldb_129
Lps_133:
    s_call_b64 s[58:59], L_seg
    s_branch Lpk_132
Lgs_136:
    s_mov_b32 s41, s24
    s_min_u32 s51, s56, s82
    s_add_u32 s51, s51, 8
    s_min_u32 s51, s51, 13
Lgw_134:
    s_getreg_b32 s0, hwreg(HW_REG_IB_STS)
    s_and_b32 s0, s0, 0xc0000f
    s_sub_u32 s1, s24, s41
    s_cmp_le_u32 s0, s1
    s_cselect_b32 s100, s41, s100
    s_cbranch_scc1 Lgd_135
    s_cmp_ge_u32 s24, s25
    s_cbranch_scc1 Lgv_137
    s_cmp_gt_u32 s0, s51
    s_cbranch_scc1 Lgw_134
    s_mov_b32 m0, s26
    s_add_u32 s0, s16, s101
    s_addc_u32 s1, s17, 0
    s_add_u32 s24, s24, 2
    global_load_lds_dwordx4 v8, s[0:1] nt
    global_load_lds_dwordx4 v9, s[0:1] offset:1024 nt
    s_add_u32 s101, s101, 65536
    s_and_b32 s101, s101, 0x7ffff
    s_add_u32 s26, s26, 2048
    s_and_b32 s0, s24, 15
    s_cbranch_scc0 Lps_138
Lpb_139:
    s_branch Lgw_134
Lgv_137:
    s_call_b64 s[62:63], L_service
    s_branch Lgw_134
Lps_138:
    s_call_b64 s[58:59], L_seg
    s_branch Lpb_139
Ltg_140:
    v_bitop3_b32 v56, v22, v26, v30 bitop3:0x80
    v_bitop3_b32 v56, v56, v34, v38 bitop3:0x80
    v_bitop3_b32 v56, v56, v42, v46 bitop3:0x80
    v_bitop3_b32 v56, v56, v50, v50 bitop3:0x80
    s_branch Ltb_141
Ltr_142:
    s_mov_b64 exec, vcc
    s_branch L_gB
L_wqB:
    s_waitcnt lgkmcnt(3)
    v_mfma_f32_16x16x32_bf16 v[22:25], a[240:243], v[30:33], 0
    v_mfma_f32_16x16x32_bf16 v[26:29], a[248:251], v[30:33], 0
    s_waitcnt lgkmcnt(2)
    v_mfma_f32_16x16x32_bf16 v[22:25], a[244:247], v[34:37], v[22:25]
    v_mfma_f32_16x16x32_bf16 v[26:29], a[252:255], v[34:37], v[26:29]
    s_branch L_wqD
Lsm_143:
    global_store_dwordx4 v7, v[22:25], s[32:33] sc1
    global_store_dwordx4 v7, v[26:29], s[32:33] offset:64 sc1
    s_mov_b64 exec, s[96:97]
    v_and_or_b32 v46, v46, -2, s42
    global_store_dword v59, v46, s[32:33] offset:4 sc1
    s_branch Lsb_144
Lsv_145:
    s_call_b64 s[62:63], L_service
    s_branch Lsw_146
Lsm_147:
    global_store_dwordx2 v3, v[22:23], s[44:45] sc1
    s_mov_b64 exec, s[98:99]
    global_store_dwordx4 v7, v[30:33], s[32:33] sc1
    global_store_dwordx4 v7, v[30:33], s[32:33] offset:64 sc1
    s_mov_b64 exec, 1
    global_store_dwordx2 v57, v[42:43], s[44:45] sc1
    global_store_dwordx2 v34, v[30:31], s[32:33] sc1
    s_branch Lsb_148
Lps_150:
    s_call_b64 s[58:59], L_seg
    s_branch Lpk_149
Lps_152:
    s_call_b64 s[58:59], L_seg
    s_branch Lpk_151
Lps_154:
    s_call_b64 s[58:59], L_seg
    s_branch Lpk_153
Lps_156:
    s_call_b64 s[58:59], L_seg
    s_branch Lpk_155
Lps_158:
    s_call_b64 s[58:59], L_seg
    s_branch Lpk_157
Lps_160:
    s_call_b64 s[58:59], L_seg
    s_branch Lpk_159
Lps_162:
    s_call_b64 s[58:59], L_seg
    s_branch Lpk_161
Lps_164:
    s_call_b64 s[58:59], L_seg
    s_branch Lpk_163
Lps_166:
    s_call_b64 s[58:59], L_seg
    s_branch Lpk_165
Lps_168:
    s_call_b64 s[58:59], L_seg
    s_branch Lpk_167
Lps_170:
    s_call_b64 s[58:59], L_seg
    s_branch Lpk_169
Lps_172:
    s_call_b64 s[58:59], L_seg
    s_branch Lpk_171
L_end:

s_endpgm
.section .rodata,"a"
.p2align 6
.amdhsa_kernel interleave_layers__gqa_block_cached__gqa_block_cached__decode_kernel
  .amdhsa_next_free_vgpr 512
  .amdhsa_next_free_sgpr 102
  .amdhsa_accum_offset 256
  .amdhsa_group_segment_fixed_size 0
  .amdhsa_kernarg_size 104
  .amdhsa_user_sgpr_count 2
  .amdhsa_user_sgpr_kernarg_segment_ptr 1
  .amdhsa_system_sgpr_workgroup_id_x 1
.end_amdhsa_kernel
```
